```python
import torch

def _softmax(x, axis=-1):
    return torch.softmax(x, dim=axis)

def _gelu(x):
    return torch.nn.functional.gelu(x, approximate='tanh')

def _silu(x):
    return torch.nn.functional.silu(x)

def _sigmoid(x):
    return torch.sigmoid(x)

def _layernorm(x, axis=-1, eps=1e-05):
    m = x.mean(dim=axis, keepdim=True)
    v = x.var(dim=axis, keepdim=True, unbiased=False)
    return (x - m) / torch.sqrt(v + eps)

def _scatter_add(tgt, idx, src, axis=0):
    return tgt.clone().index_add_(axis, idx, src)

def _segment_sum(src, seg, n):
    out = torch.zeros((n,) + src.shape[1:], dtype=src.dtype)
    return out.index_add_(0, seg, src)

def _pad(x, pw):
    flat = tuple((v for pair in reversed(pw) for v in pair))
    return torch.nn.functional.pad(x, flat)
kernel_name = 'adaLN_cond__compressed_kv_cla__dense_activation_relu__decode'

def setup_inputs():

    _w = lambda a: (lambda t: t.to(torch.bfloat16) if t.is_floating_point() else t)(torch.as_tensor(a))

    def _A_setup():
        B, H, Sq, Sk, D, M = (2, 32, 1, 8192, 128, 512)
        Dc = 4 * D
        return {'x': _w((lambda *s: torch.randn(*s, dtype=torch.bfloat16) * 0.05)(B, Sq, M)), 'c_kv': _w((lambda *s: torch.randn(*s, dtype=torch.bfloat16) * 1.6)(B, Sk, Dc)), 'w_q': _w((lambda *s: torch.randn(*s, dtype=torch.bfloat16) * 1.6)(M, H, D) * M ** (-0.5)), 'w_uk': _w((lambda *s: torch.randn(*s, dtype=torch.bfloat16) * 1.6)(Dc, H, D) * Dc ** (-0.5)), 'w_uv': _w((lambda *s: torch.randn(*s, dtype=torch.bfloat16) * 1.6)(Dc, H, D) * Dc ** (-0.5)), 'w_o': _w((lambda *s: torch.randn(*s, dtype=torch.bfloat16) * 1.6)(H, D, M) * (H * D) ** (-0.5))}
    _A_in = _A_setup()

    def _B_setup():
        B, S, D, Dff = (2, 1, 512, 1792)
        return {'x': _w((lambda *s: torch.randn(*s, dtype=torch.bfloat16) * 0.05)(B, S, D)), 'w1': _w((lambda *s: torch.randn(*s, dtype=torch.bfloat16) * 0.05)(D, Dff)), 'w2': _w((lambda *s: torch.randn(*s, dtype=torch.bfloat16) * 0.05)(Dff, D))}
    _B_in = _B_setup()
    return {'A_x': _A_in['x'], 'A_c_kv': _A_in['c_kv'], 'A_w_q': _A_in['w_q'], 'A_w_uk': _A_in['w_uk'], 'A_w_uv': _A_in['w_uv'], 'A_w_o': _A_in['w_o'], 'B_x': _B_in['x'], 'B_w1': _B_in['w1'], 'B_w2': _B_in['w2'], 'c': _w((lambda *s: torch.randn(*s, dtype=torch.bfloat16) * 0.2)(2, 512) * 8.0), 'w_mod': _w((lambda *s: torch.randn(*s, dtype=torch.bfloat16) * 0.2)(512, 6 * 512) * 512 ** (-0.5) * 8.0)}

def reference(A_x, A_c_kv, A_w_q, A_w_uk, A_w_uv, A_w_o, B_x, B_w1, B_w2, c, w_mod):

    def _A_ref(x, c_kv, w_q, w_uk, w_uv, w_o):
        B, Sq, M = (x.shape[0], x.shape[1], x.shape[2])
        Sk = c_kv.shape[1]
        H, D = (w_q.shape[1], w_q.shape[2])
        q = torch.einsum('bqm,mhd->bhqd', x, w_q)
        k = torch.einsum('bkc,chd->bhkd', c_kv, w_uk)
        v = torch.einsum('bkc,chd->bhkd', c_kv, w_uv)
        scores = torch.einsum('bhqd,bhkd->bhqk', q, k) * D ** (-0.5)
        off = Sk - Sq
        qi = torch.arange(Sq)[:, None]
        kj = torch.arange(Sk)[None, :]
        cmask = kj <= qi + off
        scores = torch.where(cmask[None, None], scores, -1000000000.0)
        p = _softmax(scores, axis=-1)
        ctx = torch.einsum('bhqk,bhkd->bhqd', p, v)
        return torch.einsum('bhqd,hdm->bqm', ctx, w_o)

    def _B_ref(x, w1, w2):
        h = torch.einsum('bsd,df->bsf', x, w1)
        zero = torch.zeros_like(h)
        h = torch.maximum(h, zero)
        return torch.einsum('bsf,fd->bsd', h, w2)
    x = A_x
    mod = (_silu(c) @ w_mod).reshape(c.shape[0], 6, 1, -1)
    sa, ca, ga, sb, cb, gb = (mod[:, 0].clone(), mod[:, 1].clone(), mod[:, 2].clone(), mod[:, 3].clone(), mod[:, 4].clone(), mod[:, 5].clone())
    h = _layernorm(x, axis=-1) * (1 + ca) + sa
    x = x + ga * _A_ref(h, A_c_kv, A_w_q, A_w_uk, A_w_uv, A_w_o)
    h = _layernorm(x, axis=-1) * (1 + cb) + sb
    x = x + gb * _B_ref(h, B_w1, B_w2)
    return x
```

```asm
; @launch grid=(256,1,1) block=(256,1,1) lds=163840
.amdgcn_target "amdgcn-amd-amdhsa--gfx950"
.text
.globl adaLN_cond__compressed_kv_cla__dense_activation_relu__decode_kernel
.p2align 8
.type adaLN_cond__compressed_kv_cla__dense_activation_relu__decode_kernel,@function
adaLN_cond__compressed_kv_cla__dense_activation_relu__decode_kernel:
    s_cmp_ge_u32 s2, 256
    s_cbranch_scc1 EXIT
    s_load_dwordx16 s[4:19], s[0:1], 0
    s_load_dwordx8 s[20:27], s[0:1], 64
    s_load_dwordx4 s[28:31], s[0:1], 96
    s_and_b32 s34, s2, 8
    s_cmp_lg_u32 s34, 8
    s_cbranch_scc1 E_NOWARM
    s_getpc_b64 s[32:33]
E_PC:
    v_lshlrev_b32 v1, 6, v0
    v_min_u32 v1, EXIT-E_PC, v1
    global_load_dword v255, v1, s[32:33]
E_NOWARM:
    v_lshrrev_b32 v1, 6, v0
    v_and_b32 v0, 63, v0
    v_readfirstlane_b32 s3, v1
    s_and_b32 s56, s2, 7
    s_lshr_b32 s57, s2, 4
    s_lshl4_add_u32 s58, s56, s57
    v_lshlrev_b32 v1, 4, v0
    v_lshrrev_b32 v2, 4, v0
    v_and_b32 v3, 15, v0
    s_mov_b32 s39, 0x20000
    s_mov_b32 s43, 0x20000
    s_mov_b32 s47, 0x20000
    s_mov_b32 s51, 0x20000
    s_mov_b32 s55, 0x20000
    s_bitcmp1_b32 s2, 3
    s_cbranch_scc1 WROLE
    s_and_b32 s60, s58, 15
    s_lshr_b32 s61, s58, 4
    v_lshlrev_b32 v4, 4, v3
    v_lshl_or_b32 v68, v2, 19, v4
    v_mov_b32 v64, -1
    v_mov_b32 v65, -1
    v_mov_b32 v66, -1
    v_mov_b32 v67, -1
    s_lshl_b32 s62, s3, 15
    s_lshl_b32 s63, s58, 8
    s_add_u32 s62, s62, s63
    s_add_u32 s62, s62, 1048576
    s_cmp_ge_u32 s3, 2
    s_cbranch_scc1 A_W23
    v_lshrrev_b32 v5, 3, v0
    v_and_b32 v6, 7, v0
    v_lshlrev_b32 v7, 1, v2
    v_xor_b32 v7, v6, v7
    v_mul_u32_u24 v8, 6144, v5
    v_lshrrev_b32 v9, 2, v7
    v_lshl_add_u32 v8, v9, 10, v8
    v_and_b32 v9, 3, v7
    v_lshl_add_u32 v8, v9, 4, v8
    v_and_b32 v10, 1, v5
    v_lshlrev_b32 v10, 10, v10
    v_lshl_add_u32 v11, v2, 3, v6
    v_lshl_add_u32 v11, v11, 5, v10
    v_lshl_add_u32 v12, v2, 3, v10
    s_lshl1_add_u32 s32, s61, s3
    s_mul_i32 s32, s32, 196608
    s_lshl_b32 s33, s60, 6
    s_add_u32 s32, s32, s33
    s_lshl_b32 s34, s3, 5
    s_add_u32 s33, s33, s34
    s_lshl_b32 s34, s3, 12
    s_add_u32 m0, s34, 131072
    s_waitcnt lgkmcnt(0)
    s_mov_b64 s[44:45], s[4:5]
    s_mov_b32 s46, 2048
    s_mov_b64 s[40:41], s[24:25]
    s_mov_b32 s42, 3145728
    buffer_load_dwordx4 v[16:19], v11, s[44:47], 0 offen
    buffer_load_dwordx4 v[20:23], v11, s[44:47], 0 offen offset:16
    buffer_load_dwordx2 v[24:25], v12, s[44:47], s33 offen
    buffer_load_dwordx4 v8, s[40:43], s32 offen offset:0 nt lds
    s_add_u32 s32, s32, 48128
    buffer_load_dwordx4 v8, s[40:43], s32 offen offset:1024 nt lds
    s_add_u32 s32, s32, 48128
    buffer_load_dwordx4 v8, s[40:43], s32 offen offset:2048 nt lds
    s_add_u32 s32, s32, 48128
    buffer_load_dwordx4 v8, s[40:43], s32 offen offset:3072 nt lds
    s_load_dword s59, s[30:31], 0
    s_mov_b64 s[36:37], s[30:31]
    s_mov_b32 s38, 268435456
    v_lshrrev_b32 v13, 2, v0
    v_lshlrev_b32 v13, 7, v13
    v_and_b32 v14, 3, v5
    v_xor_b32 v14, s3, v14
    v_lshl_add_u32 v13, v14, 5, v13
    v_and_b32 v14, 3, v0
    v_lshl_add_u32 v13, v14, 3, v13
    v_add_u32 v13, 131072, v13
    v_xor_b32 v14, 64, v13
    v_lshrrev_b32 v15, 3, v10
    v_lshl_add_u32 v15, v2, 4, v15
    v_add_u32 v15, 139264, v15
    s_cmp_eq_u32 s61, 0
    s_cselect_b32 s32, 1.0, 0
    v_mov_b32 v56, s32
    v_mov_b32 v57, s32
    v_mov_b32 v58, s32
    v_mov_b32 v59, s32
    v_lshlrev_b32 v5, 4, v5
    v_lshl_add_u32 v5, v6, 15, v5
    s_lshl_b32 s32, s60, 11
    s_lshl_b32 s33, s61, 8
    s_add_u32 s32, s32, s33
    s_lshl_b32 s33, s3, 7
    s_add_u32 s32, s32, s33
    s_add_u32 s32, s32, 786432
    s_mov_b32 s33, 0x3f803f80
    v_mov_b32 v26, 0
    v_mov_b32 v27, 0
    s_mov_b32 s96, 0x1010101
    s_mov_b32 s97, 0x1010101
    s_waitcnt vmcnt(5)
    v_dot2c_f32_bf16 v26, s33, v16
    v_dot2c_f32_bf16 v27, v16, v16
    v_dot2c_f32_bf16 v26, s33, v17
    v_dot2c_f32_bf16 v27, v17, v17
    v_dot2c_f32_bf16 v26, s33, v18
    v_dot2c_f32_bf16 v27, v18, v18
    v_dot2c_f32_bf16 v26, s33, v19
    v_dot2c_f32_bf16 v27, v19, v19
    v_dot2c_f32_bf16 v26, s33, v20
    v_dot2c_f32_bf16 v27, v20, v20
    v_dot2c_f32_bf16 v26, s33, v21
    v_dot2c_f32_bf16 v27, v21, v21
    v_dot2c_f32_bf16 v26, s33, v22
    v_dot2c_f32_bf16 v27, v22, v22
    v_dot2c_f32_bf16 v26, s33, v23
    v_dot2c_f32_bf16 v27, v23, v23
    s_nop 1
    v_add_f32_dpp v26, v26, v26 quad_perm:[1,0,3,2] row_mask:0xf bank_mask:0xf
    v_add_f32_dpp v27, v27, v27 quad_perm:[1,0,3,2] row_mask:0xf bank_mask:0xf
    s_nop 0
    v_add_f32_dpp v26, v26, v26 quad_perm:[2,3,0,1] row_mask:0xf bank_mask:0xf
    v_add_f32_dpp v27, v27, v27 quad_perm:[2,3,0,1] row_mask:0xf bank_mask:0xf
    s_nop 0
    v_add_f32_dpp v26, v26, v26 row_half_mirror row_mask:0xf bank_mask:0xf
    v_add_f32_dpp v27, v27, v27 row_half_mirror row_mask:0xf bank_mask:0xf
    v_mov_b32 v16, v26
    v_mov_b32 v17, v27
    s_nop 0
    v_permlane16_swap_b32 v26, v16
    v_permlane16_swap_b32 v27, v17
    v_add_f32 v26, v26, v16
    v_add_f32 v27, v27, v17
    v_mov_b32 v16, v26
    v_mov_b32 v17, v27
    s_nop 0
    v_permlane32_swap_b32 v26, v16
    v_permlane32_swap_b32 v27, v17
    v_add_f32 v26, v26, v16
    v_add_f32 v27, v27, v17
    v_mul_f32 v26, 0x3b000000, v26
    v_mov_b32 v16, 0x3727c5ac
    v_fmac_f32 v16, 0x3b000000, v27
    v_fma_f32 v16, -v26, v26, v16
    v_rsq_f32 v16, v16
    s_waitcnt vmcnt(4)
    v_lshlrev_b32 v20, 16, v24
    v_and_b32 v21, 0xffff0000, v24
    v_lshlrev_b32 v22, 16, v25
    v_and_b32 v23, 0xffff0000, v25
    v_sub_f32 v20, v20, v26
    v_sub_f32 v21, v21, v26
    v_sub_f32 v22, v22, v26
    v_sub_f32 v23, v23, v26
    v_mul_f32 v20, v20, v16
    v_mul_f32 v21, v21, v16
    v_mul_f32 v22, v22, v16
    v_mul_f32 v23, v23, v16
    s_waitcnt vmcnt(0) lgkmcnt(0)
    s_barrier
    ds_read_b128 v[44:47], v15
    ds_read_b64_tr_b16 v[28:29], v13 offset:0
    ds_read_b64_tr_b16 v[30:31], v13 offset:2048
    ds_read_b64_tr_b16 v[32:33], v14 offset:0
    ds_read_b64_tr_b16 v[34:35], v14 offset:2048
    ds_read_b128 v[48:51], v15 offset:64
    ds_read_b64_tr_b16 v[36:37], v13 offset:4096
    ds_read_b64_tr_b16 v[38:39], v13 offset:6144
    ds_read_b64_tr_b16 v[40:41], v14 offset:4096
    ds_read_b64_tr_b16 v[42:43], v14 offset:6144
    s_add_u32 s59, s59, 0x9e3779b9
    v_mov_b32 v62, s59
    v_mov_b32 v63, s59
    s_waitcnt lgkmcnt(7)
    v_mfma_f32_16x16x32_bf16 v[52:55], v[28:31], v[44:47], 0
    s_waitcnt lgkmcnt(5)
    v_mfma_f32_16x16x32_bf16 v[56:59], v[32:35], v[44:47], v[56:59]
    s_waitcnt lgkmcnt(2)
    v_mfma_f32_16x16x32_bf16 v[52:55], v[36:39], v[48:51], v[52:55]
    s_waitcnt lgkmcnt(0)
    v_mfma_f32_16x16x32_bf16 v[56:59], v[40:43], v[48:51], v[56:59]
    s_mov_b64 exec, s[96:97]
    s_nop 6
    v_pk_fma_f32 v[52:53], v[20:21], v[56:57], v[52:53]
    v_pk_fma_f32 v[54:55], v[22:23], v[58:59], v[54:55]
    v_cvt_pk_bf16_f32 v60, v52, v53
    v_cvt_pk_bf16_f32 v61, v54, v55
    buffer_store_dwordx4 v[60:63], v5, s[36:39], s32 offen sc1
    s_mov_b64 exec, -1
    s_branch A_STREAM
A_W23:
    s_cmp_eq_u32 s3, 3
    s_cbranch_scc1 A_W3
    v_lshrrev_b32 v5, 5, v0
    v_and_b32 v6, 31, v0
    v_lshlrev_b32 v7, 2, v6
    v_lshl_add_u32 v7, v5, 10, v7
    s_lshl_b32 s32, s61, 7
    s_waitcnt lgkmcnt(0)
    s_mov_b64 s[48:49], s[22:23]
    s_mov_b32 s50, 2048
    buffer_load_dword v16, v7, s[48:51], s32 offen
    s_load_dword s59, s[30:31], 0
    s_mov_b64 s[36:37], s[30:31]
    s_mov_b32 s38, 268435456
    v_lshlrev_b32 v8, 6, v2
    v_bfe_u32 v9, v0, 1, 2
    v_lshl_add_u32 v8, v9, 4, v8
    v_and_b32 v9, 8, v0
    v_add_u32 v8, v8, v9
    v_and_b32 v9, 1, v0
    v_lshl_add_u32 v8, v9, 2, v8
    v_add_u32 v8, 139264, v8
    s_waitcnt vmcnt(0)
    v_lshlrev_b32 v20, 16, v16
    v_and_b32 v21, 0xffff0000, v16
    v_mul_f32 v22, 0xbfb8aa3b, v20
    v_mul_f32 v23, 0xbfb8aa3b, v21
    v_exp_f32 v22, v22
    v_exp_f32 v23, v23
    v_add_f32 v22, 1.0, v22
    v_add_f32 v23, 1.0, v23
    v_rcp_f32 v22, v22
    v_rcp_f32 v23, v23
    v_mul_f32 v20, v20, v22
    v_mul_f32 v21, v21, v23
    v_cvt_pk_bf16_f32 v16, v20, v21
    ds_write_b32 v8, v16
    s_branch A_W23B
A_W3:
    s_mul_i32 s32, s58, 2048
    s_add_u32 s32, s32, 393216
    s_waitcnt lgkmcnt(0)
    s_mov_b64 s[36:37], s[30:31]
    s_mov_b32 s38, 268435456
    buffer_store_dwordx4 v[64:67], v1, s[36:39], s32 offen sc1
    buffer_store_dwordx4 v[64:67], v1, s[36:39], s32 offen offset:1024 sc1
    s_load_dword s59, s[30:31], 0
    s_waitcnt vmcnt(0)
A_W23B:
    s_waitcnt lgkmcnt(0)
    s_barrier
    s_add_u32 s59, s59, 0x9e3779b9
A_STREAM:
    s_mov_b64 s[52:53], s[6:7]
    s_mov_b32 s54, 16777216
    s_lshl_b32 s32, s58, 17
    s_lshl_b32 s33, s3, 15
    s_add_u32 s32, s32, s33
    s_add_u32 m0, s33, 0
    v_xor_b32 v70, 0, v1
    buffer_load_dwordx4 v70, s[52:55], s32 offen offset:0 nt lds
    v_xor_b32 v71, 32, v1
    buffer_load_dwordx4 v71, s[52:55], s32 offen offset:1024 nt lds
    v_xor_b32 v72, 64, v1
    buffer_load_dwordx4 v72, s[52:55], s32 offen offset:2048 nt lds
    v_xor_b32 v73, 96, v1
    buffer_load_dwordx4 v73, s[52:55], s32 offen offset:3072 nt lds
    s_add_u32 m0, s33, 4096
    v_xor_b32 v74, 4224, v1
    buffer_load_dwordx4 v74, s[52:55], s32 offen offset:0 nt lds
    v_xor_b32 v75, 4256, v1
    buffer_load_dwordx4 v75, s[52:55], s32 offen offset:1024 nt lds
    v_xor_b32 v76, 4288, v1
    buffer_load_dwordx4 v76, s[52:55], s32 offen offset:2048 nt lds
    v_xor_b32 v77, 4320, v1
    buffer_load_dwordx4 v77, s[52:55], s32 offen offset:3072 nt lds
    s_add_u32 m0, s33, 8192
    v_xor_b32 v78, 8208, v1
    buffer_load_dwordx4 v78, s[52:55], s32 offen offset:0 nt lds
    v_xor_b32 v79, 8240, v1
    buffer_load_dwordx4 v79, s[52:55], s32 offen offset:1024 nt lds
    v_xor_b32 v80, 8272, v1
    buffer_load_dwordx4 v80, s[52:55], s32 offen offset:2048 nt lds
    v_xor_b32 v81, 8304, v1
    buffer_load_dwordx4 v81, s[52:55], s32 offen offset:3072 nt lds
    s_add_u32 m0, s33, 12288
    v_xor_b32 v82, 12432, v1
    buffer_load_dwordx4 v82, s[52:55], s32 offen offset:0 nt lds
    v_xor_b32 v83, 12464, v1
    buffer_load_dwordx4 v83, s[52:55], s32 offen offset:1024 nt lds
    v_xor_b32 v84, 12496, v1
    buffer_load_dwordx4 v84, s[52:55], s32 offen offset:2048 nt lds
    v_xor_b32 v85, 12528, v1
    buffer_load_dwordx4 v85, s[52:55], s32 offen offset:3072 nt lds
    s_add_u32 m0, s33, 16384
    s_add_u32 s32, s32, 16384
    buffer_load_dwordx4 v70, s[52:55], s32 offen offset:0 nt lds
    buffer_load_dwordx4 v71, s[52:55], s32 offen offset:1024 nt lds
    buffer_load_dwordx4 v72, s[52:55], s32 offen offset:2048 nt lds
    buffer_load_dwordx4 v73, s[52:55], s32 offen offset:3072 nt lds
    s_add_u32 m0, s33, 20480
    s_nop 0
    buffer_load_dwordx4 v74, s[52:55], s32 offen offset:0 nt lds
    buffer_load_dwordx4 v75, s[52:55], s32 offen offset:1024 nt lds
    buffer_load_dwordx4 v76, s[52:55], s32 offen offset:2048 nt lds
    buffer_load_dwordx4 v77, s[52:55], s32 offen offset:3072 nt lds
    s_add_u32 m0, s33, 24576
    s_nop 0
    buffer_load_dwordx4 v78, s[52:55], s32 offen offset:0 nt lds
    buffer_load_dwordx4 v79, s[52:55], s32 offen offset:1024 nt lds
    buffer_load_dwordx4 v80, s[52:55], s32 offen offset:2048 nt lds
    buffer_load_dwordx4 v81, s[52:55], s32 offen offset:3072 nt lds
    s_add_u32 m0, s33, 28672
    s_nop 0
    buffer_load_dwordx4 v82, s[52:55], s32 offen offset:0 nt lds
    buffer_load_dwordx4 v83, s[52:55], s32 offen offset:1024 nt lds
    buffer_load_dwordx4 v84, s[52:55], s32 offen offset:2048 nt lds
    buffer_load_dwordx4 v85, s[52:55], s32 offen offset:3072 nt lds
    s_mov_b64 s[40:41], s[12:13]
    s_mov_b32 s42, 4194304
    v_and_b32 v4, 31, v0
    v_lshrrev_b32 v5, 5, v0
    v_and_b32 v6, 7, v0
    v_bfe_u32 v7, v0, 3, 1
    v_lshl_or_b32 v6, v6, 1, v7
    v_xor_b32 v6, v6, v5
    v_lshlrev_b32 v6, 4, v6
    v_lshl_add_u32 v6, v4, 10, v6
    v_add_u32 v69, s33, v6
    v_xor_b32 v6, v3, v5
    v_lshlrev_b32 v6, 4, v6
    v_lshl_add_u32 v6, v4, 8, v6
    v_add_u32 v70, 131072, v6
    v_xor_b32 v71, 32, v70
    v_xor_b32 v72, 64, v70
    v_xor_b32 v73, 96, v70
    v_xor_b32 v74, 128, v70
    v_xor_b32 v75, 160, v70
    v_xor_b32 v76, 192, v70
    v_xor_b32 v77, 224, v70
    v_bfe_u32 v6, v0, 2, 3
    v_lshl_add_u32 v7, v5, 4, v6
    v_lshlrev_b32 v7, 10, v7
    v_lshl_add_u32 v7, v6, 5, v7
    v_and_b32 v6, 3, v0
    v_lshl_add_u32 v7, v6, 3, v7
    s_lshl_b32 s32, s3, 8
    v_add_u32 v78, s32, v7
    v_xor_b32 v6, v3, v2
    v_lshlrev_b32 v6, 4, v6
    v_lshl_add_u32 v124, v2, 8, v6
    v_xor_b32 v125, 64, v124
    v_xor_b32 v126, 128, v124
    v_xor_b32 v127, 192, v124
    v_lshlrev_b32 v6, 4, v3
    v_lshl_add_u32 v82, v2, 13, v6
    s_lshl_b32 s32, s3, 7
    s_and_b32 s32, s32, 128
    v_xor_b32 v82, s32, v82
    v_xor_b32 v12, 64, v82
    v_lshlrev_b32 v83, 2, v4
    v_add_u32 v83, 32768, v83
    s_lshl_b32 s32, s3, 2
    s_add_u32 s32, s32, 49152
    v_lshlrev_b32 v6, 4, v4
    v_add_u32 v8, s32, v6
    v_add_u32 v9, 49152, v6
    s_lshl_b32 s32, s3, 11
    s_add_u32 s32, s32, 131072
    v_add_u32 v10, s32, v1
    v_lshlrev_b32 v6, 4, v3
    v_lshl_add_u32 v6, v2, 9, v6
    v_add_u32 v11, 131072, v6
    s_lshr_b32 s60, s58, 6
    s_lshl2_add_u32 s60, s60, s3
    s_lshl_b32 s60, s60, 13
    s_add_u32 s60, s60, 393216
    s_and_b32 s63, s58, 3
    s_lshl2_add_u32 s63, s63, s3
    s_lshl_b32 s63, s63, 18
    s_lshr_b32 s32, s58, 2
    s_lshl_b32 s32, s32, 8
    s_add_u32 s63, s63, s32
    s_lshr_b32 s61, s58, 2
    s_lshl2_add_u32 s61, s61, s3
    s_lshl_b32 s61, s61, 7
    s_add_u32 s61, s61, 65536
    s_add_u32 s2, s61, 64
    s_mov_b32 s0, s59
    s_mov_b32 s1, s59
    s_lshl2_add_u32 s32, s58, s3
    s_lshl_b32 s32, s32, 7
    s_add_u32 s32, s32, 5373952
    v_lshl_add_u32 v14, v3, 2, s32
    v_mov_b32 v13, s59
    s_movk_i32 s57, 20000
A_FPOLL:
    s_buffer_load_dwordx16 s[4:19], s[36:39], s61 glc
    s_buffer_load_dwordx16 s[20:35], s[36:39], s2 glc
    s_sub_u32 s57, s57, 1
    s_cbranch_scc1 A_FTIME
    s_waitcnt lgkmcnt(0)
    s_cmp_lg_u64 s[4:5], s[0:1]
    s_cbranch_scc1 A_FPOLL
    s_cmp_lg_u64 s[6:7], s[0:1]
    s_cbranch_scc1 A_FPOLL
    s_cmp_lg_u64 s[8:9], s[0:1]
    s_cbranch_scc1 A_FPOLL
    s_cmp_lg_u64 s[10:11], s[0:1]
    s_cbranch_scc1 A_FPOLL
    s_cmp_lg_u64 s[12:13], s[0:1]
    s_cbranch_scc1 A_FPOLL
    s_cmp_lg_u64 s[14:15], s[0:1]
    s_cbranch_scc1 A_FPOLL
    s_cmp_lg_u64 s[16:17], s[0:1]
    s_cbranch_scc1 A_FPOLL
    s_cmp_lg_u64 s[18:19], s[0:1]
    s_cbranch_scc1 A_FPOLL
    s_cmp_lg_u64 s[20:21], s[0:1]
    s_cbranch_scc1 A_FPOLL
    s_cmp_lg_u64 s[22:23], s[0:1]
    s_cbranch_scc1 A_FPOLL
    s_cmp_lg_u64 s[24:25], s[0:1]
    s_cbranch_scc1 A_FPOLL
    s_cmp_lg_u64 s[26:27], s[0:1]
    s_cbranch_scc1 A_FPOLL
    s_cmp_lg_u64 s[28:29], s[0:1]
    s_cbranch_scc1 A_FPOLL
    s_cmp_lg_u64 s[30:31], s[0:1]
    s_cbranch_scc1 A_FPOLL
    s_cmp_lg_u64 s[32:33], s[0:1]
    s_cbranch_scc1 A_FPOLL
    s_cmp_lg_u64 s[34:35], s[0:1]
    s_cbranch_scc1 A_FPOLL
A_FTIME:
    s_waitcnt lgkmcnt(0)
    s_movk_i32 s57, 2000
A_QDMA:
    s_lshl_b32 s32, s3, 13
    s_add_u32 m0, s32, 131072
    s_add_u32 s33, s60, 4096
    buffer_load_dwordx4 v124, s[36:39], s60 offen offset:0 sc1 lds
    buffer_load_dwordx4 v125, s[36:39], s60 offen offset:1024 sc1 lds
    buffer_load_dwordx4 v126, s[36:39], s60 offen offset:2048 sc1 lds
    buffer_load_dwordx4 v127, s[36:39], s60 offen offset:3072 sc1 lds
    s_add_u32 m0, s32, 135168
    s_nop 0
    buffer_load_dwordx4 v124, s[36:39], s33 offen offset:0 sc1 lds
    buffer_load_dwordx4 v125, s[36:39], s33 offen offset:1024 sc1 lds
    buffer_load_dwordx4 v126, s[36:39], s33 offen offset:2048 sc1 lds
    buffer_load_dwordx4 v127, s[36:39], s33 offen offset:3072 sc1 lds
    s_cmpk_lg_u32 s57, 2000
    s_cbranch_scc1 A_QW0
    s_waitcnt vmcnt(8)
    ds_read_b128 a[0:3], v69 offset:0
    ds_read_b128 a[32:35], v69 offset:256
    ds_read_b128 a[64:67], v69 offset:512
    ds_read_b128 a[96:99], v69 offset:768
    v_xor_b32 v80, 32, v69
    ds_read_b128 a[4:7], v80 offset:0
    ds_read_b128 a[36:39], v80 offset:256
    ds_read_b128 a[68:71], v80 offset:512
    ds_read_b128 a[100:103], v80 offset:768
    v_xor_b32 v79, 64, v69
    ds_read_b128 a[8:11], v79 offset:0
    ds_read_b128 a[40:43], v79 offset:256
    ds_read_b128 a[72:75], v79 offset:512
    ds_read_b128 a[104:107], v79 offset:768
    v_xor_b32 v80, 96, v69
    ds_read_b128 a[12:15], v80 offset:0
    ds_read_b128 a[44:47], v80 offset:256
    ds_read_b128 a[76:79], v80 offset:512
    ds_read_b128 a[108:111], v80 offset:768
    v_xor_b32 v79, 128, v69
    ds_read_b128 a[16:19], v79 offset:0
    ds_read_b128 a[48:51], v79 offset:256
    ds_read_b128 a[80:83], v79 offset:512
    ds_read_b128 a[112:115], v79 offset:768
    v_xor_b32 v80, 160, v69
    ds_read_b128 a[20:23], v80 offset:0
    ds_read_b128 a[52:55], v80 offset:256
    ds_read_b128 a[84:87], v80 offset:512
    ds_read_b128 a[116:119], v80 offset:768
    v_xor_b32 v79, 192, v69
    ds_read_b128 a[24:27], v79 offset:0
    ds_read_b128 a[56:59], v79 offset:256
    ds_read_b128 a[88:91], v79 offset:512
    ds_read_b128 a[120:123], v79 offset:768
    v_xor_b32 v80, 224, v69
    ds_read_b128 a[28:31], v80 offset:0
    ds_read_b128 a[60:63], v80 offset:256
    ds_read_b128 a[92:95], v80 offset:512
    ds_read_b128 a[124:127], v80 offset:768
    s_barrier
    v_xor_b32 v79, 0, v78
    ds_read_b64_tr_b16 a[128:129], v79 offset:0
    ds_read_b64_tr_b16 a[160:161], v79 offset:32768
    v_xor_b32 v80, 16, v78
    ds_read_b64_tr_b16 a[130:131], v80 offset:8192
    ds_read_b64_tr_b16 a[162:163], v80 offset:40960
    v_xor_b32 v79, 32, v78
    ds_read_b64_tr_b16 a[132:133], v79 offset:0
    ds_read_b64_tr_b16 a[164:165], v79 offset:32768
    v_xor_b32 v80, 48, v78
    ds_read_b64_tr_b16 a[134:135], v80 offset:8192
    ds_read_b64_tr_b16 a[166:167], v80 offset:40960
    v_xor_b32 v79, 64, v78
    ds_read_b64_tr_b16 a[136:137], v79 offset:0
    ds_read_b64_tr_b16 a[168:169], v79 offset:32768
    v_xor_b32 v80, 80, v78
    ds_read_b64_tr_b16 a[138:139], v80 offset:8192
    ds_read_b64_tr_b16 a[170:171], v80 offset:40960
    v_xor_b32 v79, 96, v78
    ds_read_b64_tr_b16 a[140:141], v79 offset:0
    ds_read_b64_tr_b16 a[172:173], v79 offset:32768
    v_xor_b32 v80, 112, v78
    ds_read_b64_tr_b16 a[142:143], v80 offset:8192
    ds_read_b64_tr_b16 a[174:175], v80 offset:40960
    v_xor_b32 v79, 128, v78
    ds_read_b64_tr_b16 a[144:145], v79 offset:0
    ds_read_b64_tr_b16 a[176:177], v79 offset:32768
    v_xor_b32 v80, 144, v78
    ds_read_b64_tr_b16 a[146:147], v80 offset:8192
    ds_read_b64_tr_b16 a[178:179], v80 offset:40960
    v_xor_b32 v79, 160, v78
    ds_read_b64_tr_b16 a[148:149], v79 offset:0
    ds_read_b64_tr_b16 a[180:181], v79 offset:32768
    v_xor_b32 v80, 176, v78
    ds_read_b64_tr_b16 a[150:151], v80 offset:8192
    ds_read_b64_tr_b16 a[182:183], v80 offset:40960
    v_xor_b32 v79, 192, v78
    ds_read_b64_tr_b16 a[152:153], v79 offset:0
    ds_read_b64_tr_b16 a[184:185], v79 offset:32768
    v_xor_b32 v80, 208, v78
    ds_read_b64_tr_b16 a[154:155], v80 offset:8192
    ds_read_b64_tr_b16 a[186:187], v80 offset:40960
    v_xor_b32 v79, 224, v78
    ds_read_b64_tr_b16 a[156:157], v79 offset:0
    ds_read_b64_tr_b16 a[188:189], v79 offset:32768
    v_xor_b32 v80, 240, v78
    ds_read_b64_tr_b16 a[158:159], v80 offset:8192
    ds_read_b64_tr_b16 a[190:191], v80 offset:40960
A_QW:
    v_mov_b32 v81, 0
    s_waitcnt vmcnt(0) lgkmcnt(0)
    s_barrier
    ds_read_b128 v[84:87], v70 offset:0
    ds_read_b128 v[88:91], v71 offset:0
    ds_read_b128 v[92:95], v72 offset:0
    ds_read_b128 v[96:99], v73 offset:0
    ds_read_b128 v[100:103], v74 offset:0
    s_waitcnt lgkmcnt(4)
    v_mfma_f32_32x32x16_bf16 v[108:123], a[0:3], v[84:87], 0
    ds_read_b128 v[104:107], v75 offset:0
    v_max3_u32 v81, v81, v84, v86
    v_xor_b32 v79, 65536, v78
    ds_read_b64_tr_b16 a[192:193], v79 offset:0
    ds_read_b64_tr_b16 a[224:225], v79 offset:32768
    s_waitcnt lgkmcnt(6)
    v_mfma_f32_32x32x16_bf16 v[108:123], a[4:7], v[88:91], v[108:123]
    ds_read_b128 v[84:87], v76 offset:0
    v_max3_u32 v81, v81, v88, v90
    v_xor_b32 v80, 65552, v78
    ds_read_b64_tr_b16 a[194:195], v80 offset:8192
    s_waitcnt lgkmcnt(7)
    v_mfma_f32_32x32x16_bf16 v[108:123], a[8:11], v[92:95], v[108:123]
    ds_read_b128 v[88:91], v77 offset:0
    v_max3_u32 v81, v81, v92, v94
    ds_read_b64_tr_b16 a[226:227], v80 offset:40960
    s_waitcnt lgkmcnt(8)
    v_mfma_f32_32x32x16_bf16 v[108:123], a[12:15], v[96:99], v[108:123]
    ds_read_b128 v[92:95], v70 offset:8192
    v_max3_u32 v81, v81, v96, v98
    v_xor_b32 v79, 65568, v78
    ds_read_b64_tr_b16 a[196:197], v79 offset:0
    s_waitcnt lgkmcnt(9)
    v_mfma_f32_32x32x16_bf16 v[108:123], a[16:19], v[100:103], v[108:123]
    ds_read_b128 v[96:99], v71 offset:8192
    v_max3_u32 v81, v81, v100, v102
    ds_read_b64_tr_b16 a[228:229], v79 offset:32768
    s_waitcnt lgkmcnt(10)
    v_mfma_f32_32x32x16_bf16 v[108:123], a[20:23], v[104:107], v[108:123]
    ds_read_b128 v[100:103], v72 offset:8192
    v_max3_u32 v81, v81, v104, v106
    v_xor_b32 v80, 65584, v78
    ds_read_b64_tr_b16 a[198:199], v80 offset:8192
    s_waitcnt lgkmcnt(9)
    v_mfma_f32_32x32x16_bf16 v[108:123], a[24:27], v[84:87], v[108:123]
    ds_read_b128 v[104:107], v73 offset:8192
    v_max3_u32 v81, v81, v84, v86
    ds_read_b64_tr_b16 a[230:231], v80 offset:40960
    s_waitcnt lgkmcnt(9)
    v_mfma_f32_32x32x16_bf16 v[108:123], a[28:31], v[88:91], v[108:123]
    ds_read_b128 v[84:87], v74 offset:8192
    v_max3_u32 v81, v81, v88, v90
    v_xor_b32 v79, 65600, v78
    ds_read_b64_tr_b16 a[200:201], v79 offset:0
    ds_read_b64_tr_b16 a[232:233], v79 offset:32768
    s_waitcnt lgkmcnt(10)
    v_mfma_f32_32x32x16_bf16 v[108:123], a[32:35], v[92:95], v[108:123]
    ds_read_b128 v[88:91], v75 offset:8192
    v_max3_u32 v81, v81, v92, v94
    v_xor_b32 v80, 65616, v78
    ds_read_b64_tr_b16 a[202:203], v80 offset:8192
    s_waitcnt lgkmcnt(10)
    v_mfma_f32_32x32x16_bf16 v[108:123], a[36:39], v[96:99], v[108:123]
    ds_read_b128 v[92:95], v76 offset:8192
    v_max3_u32 v81, v81, v96, v98
    ds_read_b64_tr_b16 a[234:235], v80 offset:40960
    s_waitcnt lgkmcnt(10)
    v_mfma_f32_32x32x16_bf16 v[108:123], a[40:43], v[100:103], v[108:123]
    ds_read_b128 v[96:99], v77 offset:8192
    v_max3_u32 v81, v81, v100, v102
    v_xor_b32 v79, 65632, v78
    ds_read_b64_tr_b16 a[204:205], v79 offset:0
    s_waitcnt lgkmcnt(10)
    v_mfma_f32_32x32x16_bf16 v[108:123], a[44:47], v[104:107], v[108:123]
    ds_read_b128 v[100:103], v70 offset:16384
    v_max3_u32 v81, v81, v104, v106
    ds_read_b64_tr_b16 a[236:237], v79 offset:32768
    s_waitcnt lgkmcnt(10)
    v_mfma_f32_32x32x16_bf16 v[108:123], a[48:51], v[84:87], v[108:123]
    ds_read_b128 v[104:107], v71 offset:16384
    v_max3_u32 v81, v81, v84, v86
    v_xor_b32 v80, 65648, v78
    ds_read_b64_tr_b16 a[206:207], v80 offset:8192
    s_waitcnt lgkmcnt(9)
    v_mfma_f32_32x32x16_bf16 v[108:123], a[52:55], v[88:91], v[108:123]
    ds_read_b128 v[84:87], v72 offset:16384
    v_max3_u32 v81, v81, v88, v90
    ds_read_b64_tr_b16 a[238:239], v80 offset:40960
    s_waitcnt lgkmcnt(9)
    v_mfma_f32_32x32x16_bf16 v[108:123], a[56:59], v[92:95], v[108:123]
    ds_read_b128 v[88:91], v73 offset:16384
    v_max3_u32 v81, v81, v92, v94
    v_xor_b32 v79, 65664, v78
    ds_read_b64_tr_b16 a[208:209], v79 offset:0
    ds_read_b64_tr_b16 a[240:241], v79 offset:32768
    s_waitcnt lgkmcnt(10)
    v_mfma_f32_32x32x16_bf16 v[108:123], a[60:63], v[96:99], v[108:123]
    ds_read_b128 v[92:95], v74 offset:16384
    v_max3_u32 v81, v81, v96, v98
    v_xor_b32 v80, 65680, v78
    ds_read_b64_tr_b16 a[210:211], v80 offset:8192
    s_waitcnt lgkmcnt(10)
    v_mfma_f32_32x32x16_bf16 v[108:123], a[64:67], v[100:103], v[108:123]
    ds_read_b128 v[96:99], v75 offset:16384
    v_max3_u32 v81, v81, v100, v102
    ds_read_b64_tr_b16 a[242:243], v80 offset:40960
    s_waitcnt lgkmcnt(10)
    v_mfma_f32_32x32x16_bf16 v[108:123], a[68:71], v[104:107], v[108:123]
    ds_read_b128 v[100:103], v76 offset:16384
    v_max3_u32 v81, v81, v104, v106
    v_xor_b32 v79, 65696, v78
    ds_read_b64_tr_b16 a[212:213], v79 offset:0
    s_waitcnt lgkmcnt(10)
    v_mfma_f32_32x32x16_bf16 v[108:123], a[72:75], v[84:87], v[108:123]
    ds_read_b128 v[104:107], v77 offset:16384
    v_max3_u32 v81, v81, v84, v86
    ds_read_b64_tr_b16 a[244:245], v79 offset:32768
    s_waitcnt lgkmcnt(10)
    v_mfma_f32_32x32x16_bf16 v[108:123], a[76:79], v[88:91], v[108:123]
    ds_read_b128 v[84:87], v70 offset:24576
    v_max3_u32 v81, v81, v88, v90
    v_xor_b32 v80, 65712, v78
    ds_read_b64_tr_b16 a[214:215], v80 offset:8192
    s_waitcnt lgkmcnt(9)
    v_mfma_f32_32x32x16_bf16 v[108:123], a[80:83], v[92:95], v[108:123]
    ds_read_b128 v[88:91], v71 offset:24576
    v_max3_u32 v81, v81, v92, v94
    ds_read_b64_tr_b16 a[246:247], v80 offset:40960
    s_waitcnt lgkmcnt(9)
    v_mfma_f32_32x32x16_bf16 v[108:123], a[84:87], v[96:99], v[108:123]
    ds_read_b128 v[92:95], v72 offset:24576
    v_max3_u32 v81, v81, v96, v98
    v_xor_b32 v79, 65728, v78
    ds_read_b64_tr_b16 a[216:217], v79 offset:0
    ds_read_b64_tr_b16 a[248:249], v79 offset:32768
    s_waitcnt lgkmcnt(10)
    v_mfma_f32_32x32x16_bf16 v[108:123], a[88:91], v[100:103], v[108:123]
    ds_read_b128 v[96:99], v73 offset:24576
    v_max3_u32 v81, v81, v100, v102
    v_xor_b32 v80, 65744, v78
    ds_read_b64_tr_b16 a[218:219], v80 offset:8192
    s_waitcnt lgkmcnt(10)
    v_mfma_f32_32x32x16_bf16 v[108:123], a[92:95], v[104:107], v[108:123]
    ds_read_b128 v[100:103], v74 offset:24576
    v_max3_u32 v81, v81, v104, v106
    ds_read_b64_tr_b16 a[250:251], v80 offset:40960
    s_waitcnt lgkmcnt(10)
    v_mfma_f32_32x32x16_bf16 v[108:123], a[96:99], v[84:87], v[108:123]
    ds_read_b128 v[104:107], v75 offset:24576
    v_max3_u32 v81, v81, v84, v86
    v_xor_b32 v79, 65760, v78
    ds_read_b64_tr_b16 a[220:221], v79 offset:0
    s_waitcnt lgkmcnt(10)
    v_mfma_f32_32x32x16_bf16 v[108:123], a[100:103], v[88:91], v[108:123]
    ds_read_b128 v[84:87], v76 offset:24576
    v_max3_u32 v81, v81, v88, v90
    ds_read_b64_tr_b16 a[252:253], v79 offset:32768
    s_waitcnt lgkmcnt(10)
    v_mfma_f32_32x32x16_bf16 v[108:123], a[104:107], v[92:95], v[108:123]
    ds_read_b128 v[88:91], v77 offset:24576
    v_max3_u32 v81, v81, v92, v94
    v_xor_b32 v80, 65776, v78
    ds_read_b64_tr_b16 a[222:223], v80 offset:8192
    s_waitcnt lgkmcnt(9)
    v_mfma_f32_32x32x16_bf16 v[108:123], a[108:111], v[96:99], v[108:123]
    v_max3_u32 v81, v81, v96, v98
    ds_read_b64_tr_b16 a[254:255], v80 offset:40960
    s_waitcnt lgkmcnt(8)
    v_mfma_f32_32x32x16_bf16 v[108:123], a[112:115], v[100:103], v[108:123]
    v_max3_u32 v81, v81, v100, v102
    s_waitcnt lgkmcnt(6)
    v_mfma_f32_32x32x16_bf16 v[108:123], a[116:119], v[104:107], v[108:123]
    v_max3_u32 v81, v81, v104, v106
    s_waitcnt lgkmcnt(4)
    v_mfma_f32_32x32x16_bf16 v[108:123], a[120:123], v[84:87], v[108:123]
    v_max3_u32 v81, v81, v84, v86
    s_waitcnt lgkmcnt(2)
    v_mfma_f32_32x32x16_bf16 v[108:123], a[124:127], v[88:91], v[108:123]
    v_max3_u32 v81, v81, v88, v90
    v_cmp_eq_u32 vcc, -1, v81
    s_cbranch_vccnz A_REDO
A_QOK:
    buffer_load_dword v13, v83, s[36:39], s61 offen sc1
    s_nop 7
    v_max3_f32 v4, v108, v109, v110
    v_max3_f32 v5, v111, v112, v113
    v_max3_f32 v4, v4, v114, v115
    v_max3_f32 v5, v5, v116, v117
    v_max3_f32 v4, v4, v118, v119
    v_max3_f32 v5, v5, v120, v121
    v_max3_f32 v4, v4, v122, v123
    v_max_f32 v4, v4, v5
    v_mov_b32 v5, v4
    s_nop 1
    v_permlane32_swap_b32 v4, v5
    v_max_f32 v4, v4, v5
    ds_write_b32 v8, v4
    s_lshl_b32 s33, s3, 13
    s_mov_b32 m0, s33
    s_mov_b32 s32, s63
    buffer_load_dwordx4 v82, s[40:43], s32 offen offset:0 nt lds
    s_add_u32 s32, s32, 31744
    buffer_load_dwordx4 v82, s[40:43], s32 offen offset:1024 nt lds
    s_add_u32 s32, s32, 31744
    buffer_load_dwordx4 v82, s[40:43], s32 offen offset:2048 nt lds
    s_add_u32 s32, s32, 31744
    buffer_load_dwordx4 v82, s[40:43], s32 offen offset:3072 nt lds
    s_add_u32 s32, s32, 35840
    s_add_u32 m0, s33, 4096
    s_nop 0
    buffer_load_dwordx4 v12, s[40:43], s32 offen offset:0 nt lds
    s_add_u32 s32, s32, 31744
    buffer_load_dwordx4 v12, s[40:43], s32 offen offset:1024 nt lds
    s_add_u32 s32, s32, 31744
    buffer_load_dwordx4 v12, s[40:43], s32 offen offset:2048 nt lds
    s_add_u32 s32, s32, 31744
    buffer_load_dwordx4 v12, s[40:43], s32 offen offset:3072 nt lds
    s_waitcnt lgkmcnt(0)
    s_barrier
    ds_read_b128 v[4:7], v9
    s_waitcnt lgkmcnt(0)
    v_max3_f32 v4, v4, v5, v6
    v_max_f32 v14, v4, v7
    v_sub_f32 v108, v108, v14
    v_sub_f32 v109, v109, v14
    v_sub_f32 v110, v110, v14
    v_sub_f32 v111, v111, v14
    v_sub_f32 v112, v112, v14
    v_sub_f32 v113, v113, v14
    v_sub_f32 v114, v114, v14
    v_sub_f32 v115, v115, v14
    v_exp_f32 v108, v108
    v_exp_f32 v109, v109
    v_exp_f32 v110, v110
    v_exp_f32 v111, v111
    v_exp_f32 v112, v112
    v_exp_f32 v113, v113
    v_exp_f32 v114, v114
    v_exp_f32 v115, v115
    v_cvt_pk_bf16_f32 v84, v108, v109
    v_cvt_pk_bf16_f32 v85, v110, v111
    v_cvt_pk_bf16_f32 v86, v112, v113
    v_cvt_pk_bf16_f32 v87, v114, v115
    ds_write_b128 v10, v[84:87] offset:0
    v_sub_f32 v116, v116, v14
    v_sub_f32 v117, v117, v14
    v_sub_f32 v118, v118, v14
    v_sub_f32 v119, v119, v14
    v_sub_f32 v120, v120, v14
    v_sub_f32 v121, v121, v14
    v_sub_f32 v122, v122, v14
    v_sub_f32 v123, v123, v14
    v_exp_f32 v116, v116
    v_exp_f32 v117, v117
    v_exp_f32 v118, v118
    v_exp_f32 v119, v119
    v_exp_f32 v120, v120
    v_exp_f32 v121, v121
    v_exp_f32 v122, v122
    v_exp_f32 v123, v123
    v_cvt_pk_bf16_f32 v88, v116, v117
    v_cvt_pk_bf16_f32 v89, v118, v119
    v_cvt_pk_bf16_f32 v90, v120, v121
    v_cvt_pk_bf16_f32 v91, v122, v123
    ds_write_b128 v10, v[88:91] offset:1024
    s_waitcnt lgkmcnt(0)
    s_barrier
    ds_read_b128 v[160:163], v11 offset:0
    ds_read_b128 v[164:167], v11 offset:2048
    ds_read_b128 v[168:171], v11 offset:4096
    ds_read_b128 v[172:175], v11 offset:6144
    ds_read_b128 v[176:179], v11 offset:256
    ds_read_b128 v[180:183], v11 offset:2304
    ds_read_b128 v[184:187], v11 offset:4352
    ds_read_b128 v[188:191], v11 offset:6400
    s_mov_b32 s33, 0x3f803f80
    v_mov_b32 v15, 0
    v_mov_b32 v16, 0
    s_lshl_b32 s34, s3, 3
    s_lshl_b32 s96, 0xff, s34
    s_mov_b32 s97, 0
    s_lshr_b32 s35, s58, 2
    s_lshl_b32 s35, s35, 11
    s_and_b32 s34, s58, 3
    s_lshl4_add_u32 s35, s34, s35
    s_add_u32 s35, s35, 5242880
    v_lshlrev_b32 v5, 6, v0
    s_mov_b32 s34, s62
    s_and_b32 s32, s3, 1
    s_lshl_b32 s0, s32, 3
    v_xor_b32 v6, s0, v0
    v_and_b32 v4, 3, v6
    v_lshrrev_b32 v6, 2, v6
    v_lshlrev_b32 v6, 11, v6
    v_lshl_add_u32 v6, v4, 4, v6
    s_lshr_b32 s1, s3, 1
    s_lshr_b32 s0, s58, 2
    s_lshl_b32 s0, s0, 6
    s_lshl_b32 s2, s1, 15
    s_add_u32 s0, s0, s2
    s_add_u32 s0, s0, 5242880
    s_lshl3_add_u32 s1, s1, s32
    s_lshl_b32 s1, s1, 11
    s_lshl_b32 s32, s58, 15
    s_add_u32 s1, s1, s32
    s_add_u32 s1, s1, 1048576
    v_lshlrev_b32 v7, 4, v3
    v_lshl_add_u32 v7, v2, 12, v7
    s_waitcnt lgkmcnt(7)
    v_mfma_f32_16x16x32_bf16 v[192:195], v[160:163], a[128:131], 0
    v_mfma_f32_16x16x32_bf16 v[196:199], v[160:163], a[132:135], 0
    s_waitcnt lgkmcnt(6)
    v_mfma_f32_16x16x32_bf16 v[192:195], v[164:167], a[160:163], v[192:195]
    v_mfma_f32_16x16x32_bf16 v[196:199], v[164:167], a[164:167], v[196:199]
    s_waitcnt lgkmcnt(5)
    v_mfma_f32_16x16x32_bf16 v[192:195], v[168:171], a[192:195], v[192:195]
    v_mfma_f32_16x16x32_bf16 v[196:199], v[168:171], a[196:199], v[196:199]
    s_waitcnt lgkmcnt(4)
    v_mfma_f32_16x16x32_bf16 v[192:195], v[172:175], a[224:227], v[192:195]
    v_mfma_f32_16x16x32_bf16 v[196:199], v[172:175], a[228:231], v[196:199]
    s_waitcnt lgkmcnt(0)
    v_mfma_f32_16x16x32_bf16 v[200:203], v[160:163], a[136:139], 0
    v_dot2c_f32_bf16 v15, s33, v160
    v_dot2c_f32_bf16 v15, s33, v161
    v_dot2c_f32_bf16 v15, s33, v162
    v_mfma_f32_16x16x32_bf16 v[204:207], v[160:163], a[140:143], 0
    v_dot2c_f32_bf16 v15, s33, v163
    v_dot2c_f32_bf16 v15, s33, v164
    v_dot2c_f32_bf16 v15, s33, v165
    v_mfma_f32_16x16x32_bf16 v[200:203], v[164:167], a[168:171], v[200:203]
    v_dot2c_f32_bf16 v15, s33, v166
    v_dot2c_f32_bf16 v15, s33, v167
    v_dot2c_f32_bf16 v15, s33, v168
    v_mfma_f32_16x16x32_bf16 v[204:207], v[164:167], a[172:175], v[204:207]
    v_dot2c_f32_bf16 v15, s33, v169
    v_dot2c_f32_bf16 v15, s33, v170
    v_dot2c_f32_bf16 v15, s33, v171
    v_mfma_f32_16x16x32_bf16 v[200:203], v[168:171], a[200:203], v[200:203]
    v_cvt_pk_bf16_f32 v84, v192, v196
    v_cvt_pk_bf16_f32 v88, v193, v197
    v_dot2c_f32_bf16 v15, s33, v172
    v_mfma_f32_16x16x32_bf16 v[204:207], v[168:171], a[204:207], v[204:207]
    v_cvt_pk_bf16_f32 v92, v194, v198
    v_cvt_pk_bf16_f32 v96, v195, v199
    v_dot2c_f32_bf16 v15, s33, v173
    v_mfma_f32_16x16x32_bf16 v[200:203], v[172:175], a[232:235], v[200:203]
    v_dot2c_f32_bf16 v15, s33, v174
    v_dot2c_f32_bf16 v15, s33, v175
    v_dot2c_f32_bf16 v16, s33, v176
    v_mfma_f32_16x16x32_bf16 v[204:207], v[172:175], a[236:239], v[204:207]
    v_dot2c_f32_bf16 v16, s33, v177
    v_dot2c_f32_bf16 v16, s33, v178
    v_dot2c_f32_bf16 v16, s33, v179
    v_mfma_f32_16x16x32_bf16 v[208:211], v[160:163], a[144:147], 0
    v_dot2c_f32_bf16 v16, s33, v180
    v_dot2c_f32_bf16 v16, s33, v181
    v_dot2c_f32_bf16 v16, s33, v182
    v_mfma_f32_16x16x32_bf16 v[212:215], v[160:163], a[148:151], 0
    v_dot2c_f32_bf16 v16, s33, v183
    v_dot2c_f32_bf16 v16, s33, v184
    v_dot2c_f32_bf16 v16, s33, v185
    v_mfma_f32_16x16x32_bf16 v[208:211], v[164:167], a[176:179], v[208:211]
    v_dot2c_f32_bf16 v16, s33, v186
    v_dot2c_f32_bf16 v16, s33, v187
    v_dot2c_f32_bf16 v16, s33, v188
    v_mfma_f32_16x16x32_bf16 v[212:215], v[164:167], a[180:183], v[212:215]
    v_dot2c_f32_bf16 v16, s33, v189
    v_dot2c_f32_bf16 v16, s33, v190
    v_dot2c_f32_bf16 v16, s33, v191
    v_mfma_f32_16x16x32_bf16 v[208:211], v[168:171], a[208:211], v[208:211]
    v_cvt_pk_bf16_f32 v85, v200, v204
    v_cvt_pk_bf16_f32 v89, v201, v205
    s_nop 0
    v_mfma_f32_16x16x32_bf16 v[212:215], v[168:171], a[212:215], v[212:215]
    v_cvt_pk_bf16_f32 v93, v202, v206
    v_cvt_pk_bf16_f32 v97, v203, v207
    v_permlane16_swap_b32 v15, v16
    v_mfma_f32_16x16x32_bf16 v[208:211], v[172:175], a[240:243], v[208:211]
    v_add_f32 v15, v15, v16
    v_mov_b32 v16, v15
    s_nop 0
    v_mfma_f32_16x16x32_bf16 v[212:215], v[172:175], a[244:247], v[212:215]
    v_permlane32_swap_b32 v15, v16
    v_add_f32 v15, v15, v16
    v_mov_b32 v16, s59
    s_mov_b64 exec, s[96:97]
    buffer_store_dwordx4 v[14:17], v5, s[36:39], s35 offen sc1
    s_mov_b64 exec, -1
    v_mfma_f32_16x16x32_bf16 v[216:219], v[160:163], a[152:155], 0
    v_mfma_f32_16x16x32_bf16 v[220:223], v[160:163], a[156:159], 0
    v_mfma_f32_16x16x32_bf16 v[216:219], v[164:167], a[184:187], v[216:219]
    v_mfma_f32_16x16x32_bf16 v[220:223], v[164:167], a[188:191], v[220:223]
    v_mfma_f32_16x16x32_bf16 v[216:219], v[168:171], a[216:219], v[216:219]
    v_cvt_pk_bf16_f32 v86, v208, v212
    v_cvt_pk_bf16_f32 v90, v209, v213
    v_mfma_f32_16x16x32_bf16 v[220:223], v[168:171], a[220:223], v[220:223]
    v_cvt_pk_bf16_f32 v94, v210, v214
    v_cvt_pk_bf16_f32 v98, v211, v215
    v_mfma_f32_16x16x32_bf16 v[216:219], v[172:175], a[248:251], v[216:219]
    v_mfma_f32_16x16x32_bf16 v[220:223], v[172:175], a[252:255], v[220:223]
    s_waitcnt vmcnt(8)
    v_cmp_ne_u32 vcc, s59, v13
    s_cbranch_vccnz A_F2POLL
A_F2OK:
    v_mfma_f32_16x16x32_bf16 v[224:227], v[176:179], a[128:131], 0
    v_mfma_f32_16x16x32_bf16 v[228:231], v[176:179], a[132:135], 0
    v_mfma_f32_16x16x32_bf16 v[224:227], v[180:183], a[160:163], v[224:227]
    v_mfma_f32_16x16x32_bf16 v[228:231], v[180:183], a[164:167], v[228:231]
    v_mfma_f32_16x16x32_bf16 v[224:227], v[184:187], a[192:195], v[224:227]
    v_cvt_pk_bf16_f32 v87, v216, v220
    buffer_store_dwordx4 v[84:87], v68, s[36:39], s34 offen sc1
    s_add_u32 s34, s34, 131072
    v_mfma_f32_16x16x32_bf16 v[228:231], v[184:187], a[196:199], v[228:231]
    v_cvt_pk_bf16_f32 v91, v217, v221
    buffer_store_dwordx4 v[88:91], v68, s[36:39], s34 offen sc1
    s_add_u32 s34, s34, 131072
    v_mfma_f32_16x16x32_bf16 v[224:227], v[188:191], a[224:227], v[224:227]
    v_cvt_pk_bf16_f32 v95, v218, v222
    buffer_store_dwordx4 v[92:95], v68, s[36:39], s34 offen sc1
    s_add_u32 s34, s34, 131072
    v_mfma_f32_16x16x32_bf16 v[228:231], v[188:191], a[228:231], v[228:231]
    v_cvt_pk_bf16_f32 v99, v219, v223
    buffer_store_dwordx4 v[96:99], v68, s[36:39], s34 offen sc1
    s_add_u32 s34, s34, 1703936
    v_mfma_f32_16x16x32_bf16 v[232:235], v[176:179], a[136:139], 0
    v_mfma_f32_16x16x32_bf16 v[236:239], v[176:179], a[140:143], 0
    v_mfma_f32_16x16x32_bf16 v[232:235], v[180:183], a[168:171], v[232:235]
    v_mfma_f32_16x16x32_bf16 v[236:239], v[180:183], a[172:175], v[236:239]
    v_mfma_f32_16x16x32_bf16 v[232:235], v[184:187], a[200:203], v[232:235]
    v_cvt_pk_bf16_f32 v100, v224, v228
    v_cvt_pk_bf16_f32 v104, v225, v229
    v_mfma_f32_16x16x32_bf16 v[236:239], v[184:187], a[204:207], v[236:239]
    v_cvt_pk_bf16_f32 v108, v226, v230
    v_cvt_pk_bf16_f32 v112, v227, v231
    v_mfma_f32_16x16x32_bf16 v[232:235], v[188:191], a[232:235], v[232:235]
    v_mfma_f32_16x16x32_bf16 v[236:239], v[188:191], a[236:239], v[236:239]
    v_mfma_f32_16x16x32_bf16 v[240:243], v[176:179], a[144:147], 0
    v_mfma_f32_16x16x32_bf16 v[244:247], v[176:179], a[148:151], 0
    v_mfma_f32_16x16x32_bf16 v[240:243], v[180:183], a[176:179], v[240:243]
    v_mfma_f32_16x16x32_bf16 v[244:247], v[180:183], a[180:183], v[244:247]
    v_mfma_f32_16x16x32_bf16 v[240:243], v[184:187], a[208:211], v[240:243]
    s_nop 2
    v_cvt_pk_bf16_f32 v101, v232, v236
    v_cvt_pk_bf16_f32 v105, v233, v237
    v_mfma_f32_16x16x32_bf16 v[244:247], v[184:187], a[212:215], v[244:247]
    v_cvt_pk_bf16_f32 v109, v234, v238
    v_cvt_pk_bf16_f32 v113, v235, v239
    v_mfma_f32_16x16x32_bf16 v[240:243], v[188:191], a[240:243], v[240:243]
    v_mfma_f32_16x16x32_bf16 v[244:247], v[188:191], a[244:247], v[244:247]
    v_mfma_f32_16x16x32_bf16 v[248:251], v[176:179], a[152:155], 0
    v_mfma_f32_16x16x32_bf16 v[252:255], v[176:179], a[156:159], 0
    v_mfma_f32_16x16x32_bf16 v[248:251], v[180:183], a[184:187], v[248:251]
    v_mfma_f32_16x16x32_bf16 v[252:255], v[180:183], a[188:191], v[252:255]
    v_mfma_f32_16x16x32_bf16 v[248:251], v[184:187], a[216:219], v[248:251]
    s_nop 2
    v_cvt_pk_bf16_f32 v102, v240, v244
    v_cvt_pk_bf16_f32 v106, v241, v245
    v_mfma_f32_16x16x32_bf16 v[252:255], v[184:187], a[220:223], v[252:255]
    v_cvt_pk_bf16_f32 v110, v242, v246
    v_cvt_pk_bf16_f32 v114, v243, v247
    v_mfma_f32_16x16x32_bf16 v[248:251], v[188:191], a[248:251], v[248:251]
    v_mfma_f32_16x16x32_bf16 v[252:255], v[188:191], a[252:255], v[252:255]
    s_nop 7
    v_cvt_pk_bf16_f32 v103, v248, v252
    buffer_store_dwordx4 v[100:103], v68, s[36:39], s34 offen sc1
    s_add_u32 s34, s34, 131072
    v_cvt_pk_bf16_f32 v107, v249, v253
    buffer_store_dwordx4 v[104:107], v68, s[36:39], s34 offen sc1
    s_add_u32 s34, s34, 131072
    v_cvt_pk_bf16_f32 v111, v250, v254
    buffer_store_dwordx4 v[108:111], v68, s[36:39], s34 offen sc1
    s_add_u32 s34, s34, 131072
    v_cvt_pk_bf16_f32 v115, v251, v255
    buffer_store_dwordx4 v[112:115], v68, s[36:39], s34 offen sc1
    v_bfe_u32 v8, v0, 2, 2
    v_xor_b32 v9, s3, v8
    v_lshlrev_b32 v9, 6, v9
    v_lshl_add_u32 v9, v8, 12, v9
    v_lshl_add_u32 v9, v2, 8, v9
    v_and_b32 v8, 3, v0
    v_lshl_add_u32 v9, v8, 4, v9
    v_mul_u32_u24 v10, 288, v8
    v_lshl_add_u32 v10, v2, 4, v10
    s_mul_i32 s32, s3, 288
    v_lshlrev_b32 v11, 4, v3
    v_lshl_add_u32 v11, v2, 3, v11
    v_add_u32 v11, s32, v11
    v_and_b32 v12, 1, v0
    v_lshlrev_b32 v12, 4, v12
    s_mov_b32 s32, 0xffff
    v_lshlrev_b32 v12, v12, s32
    v_lshrrev_b32 v13, 1, v3
    v_cmp_eq_u32 vcc, 0, v13
    s_nop 1
    v_cndmask_b32 v20, 0, v12, vcc
    v_cmp_eq_u32 vcc, 1, v13
    s_nop 1
    v_cndmask_b32 v21, 0, v12, vcc
    v_cmp_eq_u32 vcc, 2, v13
    s_nop 1
    v_cndmask_b32 v22, 0, v12, vcc
    v_cmp_eq_u32 vcc, 3, v13
    s_nop 1
    v_cndmask_b32 v23, 0, v12, vcc
    v_bfe_u32 v12, v0, 1, 1
    v_lshlrev_b32 v12, 6, v12
    v_lshl_add_u32 v12, v2, 4, v12
    s_lshl_b32 s60, s58, 9
    s_lshl_b32 s32, s3, 7
    s_add_u32 s60, s60, s32
    s_add_u32 s60, s60, 458752
    s_mov_b32 s96, 0x50005
    s_mov_b32 s97, 0x50005
    s_waitcnt vmcnt(9)
    s_barrier
    ds_read_b64_tr_b16 v[128:129], v9 offset:0
    ds_read_b64_tr_b16 v[130:131], v9 offset:16384
    ds_read_b64_tr_b16 v[132:133], v9 offset:8
    ds_read_b64_tr_b16 v[134:135], v9 offset:16392
    ds_read_b64_tr_b16 v[136:137], v9 offset:1024
    ds_read_b64_tr_b16 v[138:139], v9 offset:17408
    ds_read_b64_tr_b16 v[140:141], v9 offset:1032
    ds_read_b64_tr_b16 v[142:143], v9 offset:17416
    ds_read_b64_tr_b16 v[144:145], v9 offset:2048
    ds_read_b64_tr_b16 v[146:147], v9 offset:18432
    ds_read_b64_tr_b16 v[148:149], v9 offset:2056
    ds_read_b64_tr_b16 v[150:151], v9 offset:18440
    ds_read_b64_tr_b16 v[152:153], v9 offset:3072
    ds_read_b64_tr_b16 v[154:155], v9 offset:19456
    ds_read_b64_tr_b16 v[156:157], v9 offset:3080
    ds_read_b64_tr_b16 v[158:159], v9 offset:19464
    buffer_load_dwordx3 v[16:18], v6, s[36:39], s0 offen sc1
    s_movk_i32 s57, 20000
    s_branch MPC_2
MPL_1:
    s_sub_u32 s57, s57, 1
    s_cbranch_scc1 MPK_3
    s_mov_b64 exec, s[4:5]
    buffer_load_dwordx3 v[16:18], v6, s[36:39], s0 offen sc1
    s_mov_b64 exec, -1
MPC_2:
    s_waitcnt vmcnt(0)
    v_cmp_ne_u32 s[4:5], s59, v18
    s_or_b64 vcc, s[4:5], s[4:5]
    s_cbranch_scc1 MPL_1
MPK_3:
    buffer_load_dwordx4 v[160:163], v7, s[36:39], s1 offen offset:0 sc1
    buffer_load_dwordx4 v[164:167], v7, s[36:39], s1 offen offset:256 sc1
    buffer_load_dwordx4 v[168:171], v7, s[36:39], s1 offen offset:512 sc1
    buffer_load_dwordx4 v[172:175], v7, s[36:39], s1 offen offset:768 sc1
    buffer_load_dwordx4 v[176:179], v7, s[36:39], s1 offen offset:1024 sc1
    buffer_load_dwordx4 v[180:183], v7, s[36:39], s1 offen offset:1280 sc1
    buffer_load_dwordx4 v[184:187], v7, s[36:39], s1 offen offset:1536 sc1
    buffer_load_dwordx4 v[188:191], v7, s[36:39], s1 offen offset:1792 sc1
    v_mov_b32 v18, v16
    s_nop 1
    v_max_f32_dpp v18, v18, v18 quad_perm:[1,0,3,2] row_mask:0xf bank_mask:0xf
    s_nop 1
    v_max_f32_dpp v18, v18, v18 quad_perm:[2,3,0,1] row_mask:0xf bank_mask:0xf
    s_nop 1
    v_max_f32_dpp v18, v18, v18 row_half_mirror row_mask:0xf bank_mask:0xf
    s_nop 1
    v_max_f32_dpp v18, v18, v18 row_mirror row_mask:0xf bank_mask:0xf
    v_mov_b32 v19, v18
    s_nop 1
    v_permlane16_swap_b32 v18, v19
    v_max_f32 v18, v18, v19
    v_mov_b32 v19, v18
    s_nop 1
    v_permlane32_swap_b32 v18, v19
    v_max_f32 v18, v18, v19
    v_sub_f32 v16, v16, v18
    v_exp_f32 v16, v16
    s_nop 0
    v_mul_f32 v18, v16, v17
    s_nop 1
    v_add_f32_dpp v18, v18, v18 quad_perm:[1,0,3,2] row_mask:0xf bank_mask:0xf
    s_nop 1
    v_add_f32_dpp v18, v18, v18 quad_perm:[2,3,0,1] row_mask:0xf bank_mask:0xf
    s_nop 1
    v_add_f32_dpp v18, v18, v18 row_half_mirror row_mask:0xf bank_mask:0xf
    s_nop 1
    v_add_f32_dpp v18, v18, v18 row_mirror row_mask:0xf bank_mask:0xf
    v_mov_b32 v19, v18
    s_nop 1
    v_permlane16_swap_b32 v18, v19
    v_add_f32 v18, v18, v19
    v_mov_b32 v19, v18
    s_nop 1
    v_permlane32_swap_b32 v18, v19
    v_add_f32 v18, v18, v19
    v_rcp_f32 v18, v18
    s_nop 0
    v_mul_f32 v16, v16, v18
    v_cvt_pk_bf16_f32 v16, v16, v16
    s_nop 1
    v_and_b32_dpp v192, v16, v20 row_newbcast:0 row_mask:0xf bank_mask:0xf
    v_and_b32_dpp v193, v16, v21 row_newbcast:0 row_mask:0xf bank_mask:0xf
    v_and_b32_dpp v194, v16, v22 row_newbcast:0 row_mask:0xf bank_mask:0xf
    v_and_b32_dpp v195, v16, v23 row_newbcast:0 row_mask:0xf bank_mask:0xf
    v_and_b32_dpp v196, v16, v20 row_newbcast:1 row_mask:0xf bank_mask:0xf
    v_and_b32_dpp v197, v16, v21 row_newbcast:1 row_mask:0xf bank_mask:0xf
    v_and_b32_dpp v198, v16, v22 row_newbcast:1 row_mask:0xf bank_mask:0xf
    v_and_b32_dpp v199, v16, v23 row_newbcast:1 row_mask:0xf bank_mask:0xf
    v_and_b32_dpp v200, v16, v20 row_newbcast:2 row_mask:0xf bank_mask:0xf
    v_and_b32_dpp v201, v16, v21 row_newbcast:2 row_mask:0xf bank_mask:0xf
    v_and_b32_dpp v202, v16, v22 row_newbcast:2 row_mask:0xf bank_mask:0xf
    v_and_b32_dpp v203, v16, v23 row_newbcast:2 row_mask:0xf bank_mask:0xf
    v_and_b32_dpp v204, v16, v20 row_newbcast:3 row_mask:0xf bank_mask:0xf
    v_and_b32_dpp v205, v16, v21 row_newbcast:3 row_mask:0xf bank_mask:0xf
    v_and_b32_dpp v206, v16, v22 row_newbcast:3 row_mask:0xf bank_mask:0xf
    v_and_b32_dpp v207, v16, v23 row_newbcast:3 row_mask:0xf bank_mask:0xf
    v_and_b32_dpp v208, v16, v20 row_newbcast:4 row_mask:0xf bank_mask:0xf
    v_and_b32_dpp v209, v16, v21 row_newbcast:4 row_mask:0xf bank_mask:0xf
    v_and_b32_dpp v210, v16, v22 row_newbcast:4 row_mask:0xf bank_mask:0xf
    v_and_b32_dpp v211, v16, v23 row_newbcast:4 row_mask:0xf bank_mask:0xf
    v_and_b32_dpp v212, v16, v20 row_newbcast:5 row_mask:0xf bank_mask:0xf
    v_and_b32_dpp v213, v16, v21 row_newbcast:5 row_mask:0xf bank_mask:0xf
    v_and_b32_dpp v214, v16, v22 row_newbcast:5 row_mask:0xf bank_mask:0xf
    v_and_b32_dpp v215, v16, v23 row_newbcast:5 row_mask:0xf bank_mask:0xf
    v_and_b32_dpp v216, v16, v20 row_newbcast:6 row_mask:0xf bank_mask:0xf
    v_and_b32_dpp v217, v16, v21 row_newbcast:6 row_mask:0xf bank_mask:0xf
    v_and_b32_dpp v218, v16, v22 row_newbcast:6 row_mask:0xf bank_mask:0xf
    v_and_b32_dpp v219, v16, v23 row_newbcast:6 row_mask:0xf bank_mask:0xf
    v_and_b32_dpp v220, v16, v20 row_newbcast:7 row_mask:0xf bank_mask:0xf
    v_and_b32_dpp v221, v16, v21 row_newbcast:7 row_mask:0xf bank_mask:0xf
    v_and_b32_dpp v222, v16, v22 row_newbcast:7 row_mask:0xf bank_mask:0xf
    v_and_b32_dpp v223, v16, v23 row_newbcast:7 row_mask:0xf bank_mask:0xf
    s_movk_i32 s57, 20000
A_OWAIT:
    s_waitcnt vmcnt(0)
    v_max_u32 v18, v160, v164
    v_max3_u32 v18, v18, v168, v172
    v_max3_u32 v18, v18, v176, v180
    v_max3_u32 v18, v18, v184, v188
    v_cmp_eq_u32 vcc, -1, v18
    s_cbranch_vccnz A_OREDO
A_OOK:
    v_mfma_f32_16x16x32_bf16 v[24:27], v[192:195], v[160:163], 0
    v_mfma_f32_16x16x32_bf16 v[28:31], v[196:199], v[164:167], 0
    v_mfma_f32_16x16x32_bf16 v[24:27], v[200:203], v[168:171], v[24:27]
    v_mfma_f32_16x16x32_bf16 v[28:31], v[204:207], v[172:175], v[28:31]
    v_mfma_f32_16x16x32_bf16 v[24:27], v[208:211], v[176:179], v[24:27]
    v_mfma_f32_16x16x32_bf16 v[28:31], v[212:215], v[180:183], v[28:31]
    v_mfma_f32_16x16x32_bf16 v[24:27], v[216:219], v[184:187], v[24:27]
    v_mfma_f32_16x16x32_bf16 v[28:31], v[220:223], v[188:191], v[28:31]
    s_mov_b32 exec_hi, 0
    s_nop 6
    v_pk_add_f32 v[24:25], v[24:25], v[28:29]
    v_pk_add_f32 v[26:27], v[26:27], v[30:31]
    v_cvt_pk_bf16_f32 v24, v24, v25
    v_cvt_pk_bf16_f32 v25, v26, v27
    ds_write_b64 v11, v[24:25] offset:32768
    s_mov_b32 exec_hi, -1
    s_waitcnt lgkmcnt(0)
    s_barrier
    ds_read_b128 v[32:35], v10 offset:32768
    ds_read_b128 v[36:39], v10 offset:32832
    ds_read_b128 v[40:43], v10 offset:32896
    ds_read_b128 v[44:47], v10 offset:32960
    s_waitcnt lgkmcnt(3)
    v_mfma_f32_16x16x32_bf16 v[24:27], v[128:131], v[32:35], 0
    v_mfma_f32_16x16x32_bf16 v[28:31], v[132:135], v[32:35], 0
    s_waitcnt lgkmcnt(2)
    v_mfma_f32_16x16x32_bf16 v[24:27], v[136:139], v[36:39], v[24:27]
    v_mfma_f32_16x16x32_bf16 v[28:31], v[140:143], v[36:39], v[28:31]
    s_waitcnt lgkmcnt(1)
    v_mfma_f32_16x16x32_bf16 v[24:27], v[144:147], v[40:43], v[24:27]
    v_mfma_f32_16x16x32_bf16 v[28:31], v[148:151], v[40:43], v[28:31]
    s_waitcnt lgkmcnt(0)
    v_mfma_f32_16x16x32_bf16 v[24:27], v[152:155], v[44:47], v[24:27]
    v_mfma_f32_16x16x32_bf16 v[28:31], v[156:159], v[44:47], v[28:31]
    s_nop 6
    v_add_f32_dpp v24, v24, v24 quad_perm:[1,0,3,2] row_mask:0xf bank_mask:0xf
    v_add_f32_dpp v25, v25, v25 quad_perm:[1,0,3,2] row_mask:0xf bank_mask:0xf
    v_add_f32_dpp v26, v26, v26 quad_perm:[1,0,3,2] row_mask:0xf bank_mask:0xf
    v_add_f32_dpp v27, v27, v27 quad_perm:[1,0,3,2] row_mask:0xf bank_mask:0xf
    v_add_f32_dpp v28, v28, v28 quad_perm:[1,0,3,2] row_mask:0xf bank_mask:0xf
    v_add_f32_dpp v29, v29, v29 quad_perm:[1,0,3,2] row_mask:0xf bank_mask:0xf
    v_add_f32_dpp v30, v30, v30 quad_perm:[1,0,3,2] row_mask:0xf bank_mask:0xf
    v_add_f32_dpp v31, v31, v31 quad_perm:[1,0,3,2] row_mask:0xf bank_mask:0xf
    s_mov_b64 exec, s[96:97]
    v_cvt_pk_bf16_f32 v32, v24, v25
    v_cvt_pk_bf16_f32 v33, v26, v27
    v_cvt_pk_bf16_f32 v34, v28, v29
    v_cvt_pk_bf16_f32 v35, v30, v31
    buffer_store_dwordx4 v[32:35], v12, s[36:39], s60 offen sc1
    s_branch FIN
A_REDO:
    s_sub_u32 s57, s57, 1
    s_cbranch_scc1 A_QOK
    s_waitcnt lgkmcnt(0)
    s_barrier
    s_branch A_QDMA
A_QW0:
    s_waitcnt vmcnt(0)
    s_branch A_QW
A_OREDO:
    s_sub_u32 s57, s57, 1
    s_cbranch_scc1 A_OOK
    v_cmp_eq_u32 s[4:5], -1, v160
    v_cmp_eq_u32 s[6:7], -1, v164
    v_cmp_eq_u32 s[8:9], -1, v168
    v_cmp_eq_u32 s[10:11], -1, v172
    v_cmp_eq_u32 s[12:13], -1, v176
    v_cmp_eq_u32 s[14:15], -1, v180
    v_cmp_eq_u32 s[16:17], -1, v184
    v_cmp_eq_u32 s[18:19], -1, v188
    s_or_b64 vcc, s[4:5], s[18:19]
    s_or_b64 vcc, vcc, s[6:7]
    s_or_b64 vcc, vcc, s[8:9]
    s_or_b64 vcc, vcc, s[10:11]
    s_or_b64 vcc, vcc, s[12:13]
    s_or_b64 vcc, vcc, s[14:15]
    s_or_b64 vcc, vcc, s[16:17]
    s_mov_b64 exec, s[4:5]
    buffer_load_dwordx4 v[160:163], v7, s[36:39], s1 offen offset:0 sc1
    s_mov_b64 exec, s[6:7]
    buffer_load_dwordx4 v[164:167], v7, s[36:39], s1 offen offset:256 sc1
    s_mov_b64 exec, s[8:9]
    buffer_load_dwordx4 v[168:171], v7, s[36:39], s1 offen offset:512 sc1
    s_mov_b64 exec, s[10:11]
    buffer_load_dwordx4 v[172:175], v7, s[36:39], s1 offen offset:768 sc1
    s_mov_b64 exec, s[12:13]
    buffer_load_dwordx4 v[176:179], v7, s[36:39], s1 offen offset:1024 sc1
    s_mov_b64 exec, s[14:15]
    buffer_load_dwordx4 v[180:183], v7, s[36:39], s1 offen offset:1280 sc1
    s_mov_b64 exec, s[16:17]
    buffer_load_dwordx4 v[184:187], v7, s[36:39], s1 offen offset:1536 sc1
    s_mov_b64 exec, s[18:19]
    buffer_load_dwordx4 v[188:191], v7, s[36:39], s1 offen offset:1792 sc1
    s_mov_b64 exec, -1
    s_branch A_OWAIT
A_F2POLL:
    s_movk_i32 s57, 20000
POLL_4:
    buffer_load_dword v13, v83, s[36:39], s61 offen sc1
    s_waitcnt vmcnt(0)
    v_cmp_ne_u32 vcc, s59, v13
    s_cbranch_vccz POK_5
    s_sub_u32 s57, s57, 1
    s_cbranch_scc0 POLL_4
POK_5:
    s_branch A_F2OK
WROLE:
    s_lshr_b32 s60, s58, 2
    s_and_b32 s61, s58, 3
    s_lshl2_add_u32 s62, s61, s3
    s_lshl_b32 s32, s62, 18
    s_lshl_b32 s33, s60, 8
    s_add_u32 s32, s32, s33
    s_lshl_b32 s33, s3, 13
    s_mov_b32 m0, s33
    v_lshlrev_b32 v4, 2, v2
    v_xor_b32 v4, v4, v3
    v_lshlrev_b32 v4, 4, v4
    v_lshl_add_u32 v4, v2, 13, v4
    v_xor_b32 v5, v2, v3
    v_lshlrev_b32 v5, 4, v5
    v_lshl_add_u32 v124, v2, 13, v5
    v_xor_b32 v125, 64, v124
    v_xor_b32 v126, 128, v124
    v_xor_b32 v127, 192, v124
    s_mov_b32 s100, s32
    s_waitcnt lgkmcnt(0)
    s_mov_b64 s[40:41], s[8:9]
    s_mov_b32 s42, 4194304
    s_mov_b64 s[44:45], s[10:11]
    s_mov_b32 s46, 4194304
    buffer_load_dwordx4 v4, s[40:43], s32 offen offset:0 nt lds
    s_add_u32 s32, s32, 31744
    buffer_load_dwordx4 v4, s[40:43], s32 offen offset:1024 nt lds
    s_add_u32 s32, s32, 31744
    buffer_load_dwordx4 v4, s[40:43], s32 offen offset:2048 nt lds
    s_add_u32 s32, s32, 31744
    buffer_load_dwordx4 v4, s[40:43], s32 offen offset:3072 nt lds
    s_add_u32 s32, s32, 35840
    s_add_u32 m0, s33, 4096
    s_nop 0
    buffer_load_dwordx4 v4, s[40:43], s32 offen offset:0 nt lds
    s_add_u32 s32, s32, 31744
    buffer_load_dwordx4 v4, s[40:43], s32 offen offset:1024 nt lds
    s_add_u32 s32, s32, 31744
    buffer_load_dwordx4 v4, s[40:43], s32 offen offset:2048 nt lds
    s_add_u32 s32, s32, 31744
    buffer_load_dwordx4 v4, s[40:43], s32 offen offset:3072 nt lds
    s_add_u32 m0, s33, 32768
    s_nop 0
    buffer_load_dwordx4 v124, s[44:47], s100 offen offset:0 nt lds
    s_add_u32 s100, s100, 31744
    buffer_load_dwordx4 v124, s[44:47], s100 offen offset:1024 nt lds
    s_add_u32 s100, s100, 31744
    buffer_load_dwordx4 v125, s[44:47], s100 offen offset:2048 nt lds
    s_add_u32 s100, s100, 31744
    buffer_load_dwordx4 v125, s[44:47], s100 offen offset:3072 nt lds
    s_add_u32 s100, s100, 35840
    s_add_u32 m0, s33, 36864
    s_nop 0
    buffer_load_dwordx4 v126, s[44:47], s100 offen offset:0 nt lds
    s_add_u32 s100, s100, 31744
    buffer_load_dwordx4 v126, s[44:47], s100 offen offset:1024 nt lds
    s_add_u32 s100, s100, 31744
    buffer_load_dwordx4 v127, s[44:47], s100 offen offset:2048 nt lds
    s_add_u32 s100, s100, 31744
    buffer_load_dwordx4 v127, s[44:47], s100 offen offset:3072 nt lds
    s_load_dword s59, s[30:31], 0
    s_mov_b64 s[36:37], s[30:31]
    s_mov_b32 s38, 268435456
    v_bfe_u32 v4, v0, 2, 2
    v_xor_b32 v5, s3, v4
    v_lshlrev_b32 v5, 6, v5
    v_lshrrev_b32 v6, 2, v0
    v_lshl_add_u32 v5, v6, 8, v5
    v_and_b32 v6, 3, v0
    v_lshl_add_u32 v10, v6, 4, v5
    v_lshl_add_u32 v5, v4, 3, v6
    v_lshlrev_b32 v5, 8, v5
    v_xor_b32 v7, v2, v3
    v_lshl_add_u32 v5, v7, 4, v5
    s_add_u32 s32, s33, 32768
    v_add_u32 v11, s32, v5
    v_add_u32 v9, 131072, v1
    s_lshl_b32 s32, s3, 10
    s_add_u32 s32, s32, 131072
    v_bfe_u32 v4, v0, 1, 2
    v_lshlrev_b32 v4, 8, v4
    v_and_b32 v5, 1, v0
    v_lshl_add_u32 v4, v5, 6, v4
    v_lshl_add_u32 v4, v2, 4, v4
    v_and_b32 v6, 8, v0
    v_add3_u32 v12, v4, v6, s32
    v_bfe_u32 v4, v0, 3, 2
    v_lshlrev_b32 v4, 8, v4
    v_lshl_add_u32 v4, v5, 4, v4
    v_bfe_u32 v6, v0, 1, 1
    v_lshl_add_u32 v4, v6, 6, v4
    v_and_b32 v6, 32, v0
    v_add_u32 v4, v4, v6
    v_bfe_u32 v6, v0, 2, 1
    v_lshl_add_u32 v4, v6, 3, v4
    v_add_u32 v13, s32, v4
    v_lshrrev_b32 v4, 2, v0
    v_lshl_add_u32 v4, v4, 1, v5
    v_lshlrev_b32 v14, 4, v4
    v_lshlrev_b32 v4, 15, v6
    v_lshl_add_u32 v4, v2, 4, v4
    v_and_b32 v6, 8, v0
    v_add_u32 v15, v4, v6
    v_lshlrev_b32 v120, 9, v0
    s_lshl_b32 s62, s62, 11
    s_and_b32 s63, s56, 0
    s_lshl_b32 s63, s63, 15
    s_add_u32 s62, s62, s63
    s_add_u32 s62, s62, 786432
    s_lshl2_add_u32 s63, s60, s3
    s_lshl_b32 s63, s63, 11
    s_add_u32 s63, s63, 131072
    s_lshl_b32 s34, s61, 9
    s_add_u32 s34, s34, s63
    s_lshl_b32 s35, s61, 5
    s_add_u32 s35, s35, s60
    s_lshl_b32 s2, s35, 2
    s_add_u32 s2, s2, 65536
    s_lshl_b32 s0, s3, 12
    s_add_u32 s2, s2, s0
    s_lshl2_add_u32 s35, s35, s3
    s_lshl_b32 s35, s35, 6
    s_add_u32 s35, s35, 393216
    s_mov_b32 s0, 0xff
    s_mov_b32 s1, 0
    buffer_load_dwordx3 v[80:82], v1, s[36:39], s63 offen sc1
    buffer_load_dwordx3 v[84:86], v1, s[36:39], s63 offen offset:1024 sc1
    s_mov_b32 s96, 0x33333333
    s_mov_b32 s97, 0x33333333
    s_mov_b32 s98, 0x11111111
    s_mov_b32 s99, 0x11111111
    s_waitcnt vmcnt(10) lgkmcnt(0)
    s_add_u32 s59, s59, 0x9e3779b9
    s_barrier
    v_mov_b32 v118, s59
    v_mov_b32 v119, s59
    ds_read_b64_tr_b16 v[16:17], v10 offset:0
    ds_read_b64_tr_b16 v[18:19], v10 offset:4096
    ds_read_b64_tr_b16 v[20:21], v10 offset:8
    ds_read_b64_tr_b16 v[22:23], v10 offset:4104
    ds_read_b64_tr_b16 v[24:25], v10 offset:8192
    ds_read_b64_tr_b16 v[26:27], v10 offset:12288
    ds_read_b64_tr_b16 v[28:29], v10 offset:8200
    ds_read_b64_tr_b16 v[30:31], v10 offset:12296
    ds_read_b64_tr_b16 v[32:33], v10 offset:16384
    ds_read_b64_tr_b16 v[34:35], v10 offset:20480
    ds_read_b64_tr_b16 v[36:37], v10 offset:16392
    ds_read_b64_tr_b16 v[38:39], v10 offset:20488
    ds_read_b64_tr_b16 v[40:41], v10 offset:24576
    ds_read_b64_tr_b16 v[42:43], v10 offset:28672
    ds_read_b64_tr_b16 v[44:45], v10 offset:24584
    ds_read_b64_tr_b16 v[46:47], v10 offset:28680
    s_movk_i32 s57, 20000
POLL_6:
    buffer_load_dwordx3 v[80:82], v1, s[36:39], s62 offen sc1
    buffer_load_dwordx3 v[84:86], v1, s[36:39], s62 offen offset:1024 sc1
    s_waitcnt vmcnt(0)
    v_cmp_ne_u32 s[32:33], s59, v82
    v_cmp_ne_u32 vcc, s59, v86
    s_or_b64 vcc, vcc, s[32:33]
    s_cbranch_vccz POK_7
    s_sub_u32 s57, s57, 1
    s_cbranch_scc0 POLL_6
POK_7:
    ds_write_b64 v12, v[80:81]
    ds_write_b64 v12, v[84:85] offset:128
    s_waitcnt lgkmcnt(0)
    s_barrier
    ds_read_b128 v[88:91], v9 offset:0
    ds_read_b128 v[92:95], v9 offset:1024
    ds_read_b128 v[96:99], v9 offset:2048
    ds_read_b128 v[100:103], v9 offset:3072
    s_waitcnt lgkmcnt(3)
    v_mfma_f32_16x16x32_bf16 v[104:107], v[16:19], v[88:91], 0
    v_mfma_f32_16x16x32_bf16 v[108:111], v[20:23], v[88:91], 0
    s_waitcnt lgkmcnt(2)
    v_mfma_f32_16x16x32_bf16 v[104:107], v[24:27], v[92:95], v[104:107]
    v_mfma_f32_16x16x32_bf16 v[108:111], v[28:31], v[92:95], v[108:111]
    s_waitcnt lgkmcnt(1)
    v_mfma_f32_16x16x32_bf16 v[104:107], v[32:35], v[96:99], v[104:107]
    v_mfma_f32_16x16x32_bf16 v[108:111], v[36:39], v[96:99], v[108:111]
    s_waitcnt lgkmcnt(0)
    v_mfma_f32_16x16x32_bf16 v[104:107], v[40:43], v[100:103], v[104:107]
    v_mfma_f32_16x16x32_bf16 v[108:111], v[44:47], v[100:103], v[108:111]
    s_nop 6
    v_add_f32_dpp v112, v104, v104 row_ror:8 row_mask:0xf bank_mask:0x3
    v_add_f32_dpp v113, v105, v105 row_ror:8 row_mask:0xf bank_mask:0x3
    v_add_f32_dpp v114, v106, v106 row_ror:8 row_mask:0xf bank_mask:0x3
    v_add_f32_dpp v115, v107, v107 row_ror:8 row_mask:0xf bank_mask:0x3
    v_add_f32_dpp v112, v108, v108 row_ror:8 row_mask:0xf bank_mask:0xc
    v_add_f32_dpp v113, v109, v109 row_ror:8 row_mask:0xf bank_mask:0xc
    v_add_f32_dpp v114, v110, v110 row_ror:8 row_mask:0xf bank_mask:0xc
    v_add_f32_dpp v115, v111, v111 row_ror:8 row_mask:0xf bank_mask:0xc
    v_add_f32_dpp v112, v112, v112 quad_perm:[2,3,0,1] row_mask:0xf bank_mask:0xf
    v_add_f32_dpp v113, v113, v113 quad_perm:[2,3,0,1] row_mask:0xf bank_mask:0xf
    v_add_f32_dpp v114, v114, v114 quad_perm:[2,3,0,1] row_mask:0xf bank_mask:0xf
    v_add_f32_dpp v115, v115, v115 quad_perm:[2,3,0,1] row_mask:0xf bank_mask:0xf
    s_mov_b64 exec, s[96:97]
    v_cvt_pk_bf16_f32 v116, v112, v113
    v_cvt_pk_bf16_f32 v117, v114, v115
    buffer_store_dwordx4 v[116:119], v14, s[36:39], s34 offen sc1
    s_mov_b64 exec, -1
    ds_read_b128 v[48:51], v11 offset:0
    ds_read_b128 v[52:55], v11 offset:1024
    v_xor_b32 v4, 64, v11
    ds_read_b128 v[56:59], v4 offset:0
    ds_read_b128 v[60:63], v4 offset:1024
    v_xor_b32 v4, 128, v11
    ds_read_b128 v[64:67], v4 offset:0
    ds_read_b128 v[68:71], v4 offset:1024
    v_xor_b32 v4, 192, v11
    ds_read_b128 v[72:75], v4 offset:0
    ds_read_b128 v[76:79], v4 offset:1024
    s_movk_i32 s57, 20000
POLL_8:
    buffer_load_dwordx3 v[80:82], v1, s[36:39], s63 offen sc1
    buffer_load_dwordx3 v[84:86], v1, s[36:39], s63 offen offset:1024 sc1
    s_waitcnt vmcnt(0)
    v_cmp_ne_u32 s[32:33], s59, v82
    v_cmp_ne_u32 vcc, s59, v86
    s_or_b64 vcc, vcc, s[32:33]
    s_cbranch_vccz POK_9
    s_sub_u32 s57, s57, 1
    s_cbranch_scc0 POLL_8
POK_9:
    ds_write_b64 v13, v[80:81] offset:4096
    ds_write_b64 v13, v[84:85] offset:4224
    s_waitcnt lgkmcnt(0)
    s_barrier
    s_mov_b64 exec, s[0:1]
    buffer_store_dword v118, v120, s[36:39], s2 offen sc1
    s_mov_b64 exec, -1
    ds_read_b128 v[88:91], v9 offset:4096
    ds_read_b128 v[92:95], v9 offset:5120
    ds_read_b128 v[96:99], v9 offset:6144
    ds_read_b128 v[100:103], v9 offset:7168
    s_waitcnt lgkmcnt(3)
    v_mfma_f32_16x16x32_bf16 v[104:107], v[48:51], v[88:91], 0
    v_mfma_f32_16x16x32_bf16 v[108:111], v[52:55], v[88:91], 0
    s_waitcnt lgkmcnt(2)
    v_mfma_f32_16x16x32_bf16 v[104:107], v[56:59], v[92:95], v[104:107]
    v_mfma_f32_16x16x32_bf16 v[108:111], v[60:63], v[92:95], v[108:111]
    s_waitcnt lgkmcnt(1)
    v_mfma_f32_16x16x32_bf16 v[104:107], v[64:67], v[96:99], v[104:107]
    v_mfma_f32_16x16x32_bf16 v[108:111], v[68:71], v[96:99], v[108:111]
    s_waitcnt lgkmcnt(0)
    v_mfma_f32_16x16x32_bf16 v[104:107], v[72:75], v[100:103], v[104:107]
    v_mfma_f32_16x16x32_bf16 v[108:111], v[76:79], v[100:103], v[108:111]
    s_nop 6
    v_add_f32_dpp v112, v104, v104 row_ror:8 row_mask:0xf bank_mask:0x3
    v_add_f32_dpp v113, v105, v105 row_ror:8 row_mask:0xf bank_mask:0x3
    v_add_f32_dpp v114, v106, v106 row_ror:8 row_mask:0xf bank_mask:0x3
    v_add_f32_dpp v115, v107, v107 row_ror:8 row_mask:0xf bank_mask:0x3
    v_add_f32_dpp v112, v108, v108 row_ror:8 row_mask:0xf bank_mask:0xc
    v_add_f32_dpp v113, v109, v109 row_ror:8 row_mask:0xf bank_mask:0xc
    v_add_f32_dpp v114, v110, v110 row_ror:8 row_mask:0xf bank_mask:0xc
    v_add_f32_dpp v115, v111, v111 row_ror:8 row_mask:0xf bank_mask:0xc
    v_add_f32_dpp v112, v112, v112 quad_perm:[2,3,0,1] row_mask:0xf bank_mask:0xf
    v_add_f32_dpp v113, v113, v113 quad_perm:[2,3,0,1] row_mask:0xf bank_mask:0xf
    v_add_f32_dpp v114, v114, v114 quad_perm:[2,3,0,1] row_mask:0xf bank_mask:0xf
    v_add_f32_dpp v115, v115, v115 quad_perm:[2,3,0,1] row_mask:0xf bank_mask:0xf
    v_add_f32_dpp v112, v112, v112 quad_perm:[1,0,3,2] row_mask:0xf bank_mask:0xf
    v_add_f32_dpp v113, v113, v113 quad_perm:[1,0,3,2] row_mask:0xf bank_mask:0xf
    v_add_f32_dpp v114, v114, v114 quad_perm:[1,0,3,2] row_mask:0xf bank_mask:0xf
    v_add_f32_dpp v115, v115, v115 quad_perm:[1,0,3,2] row_mask:0xf bank_mask:0xf
    s_mov_b64 exec, s[98:99]
    v_mul_f32 v112, 0x3e0293ee, v112
    v_mul_f32 v113, 0x3e0293ee, v113
    v_mul_f32 v114, 0x3e0293ee, v114
    v_mul_f32 v115, 0x3e0293ee, v115
    v_cvt_pk_bf16_f32 v116, v112, v113
    v_cvt_pk_bf16_f32 v117, v114, v115
    buffer_store_dwordx2 v[116:117], v15, s[36:39], s35 offen sc1
    s_mov_b64 exec, -1
    v_mov_b32 v64, -1
    v_mov_b32 v65, -1
    v_mov_b32 v66, -1
    v_mov_b32 v67, -1
    s_lshl2_add_u32 s32, s58, s3
    s_lshl_b32 s32, s32, 13
    s_add_u32 s32, s32, 1048576
    s_add_u32 s34, s32, 4096
    s_add_u32 s2, s2, 32768
    buffer_store_dwordx4 v[64:67], v1, s[36:39], s32 offen offset:0 sc1
    buffer_store_dwordx4 v[64:67], v1, s[36:39], s32 offen offset:1024 sc1
    buffer_store_dwordx4 v[64:67], v1, s[36:39], s32 offen offset:2048 sc1
    buffer_store_dwordx4 v[64:67], v1, s[36:39], s32 offen offset:3072 sc1
    buffer_store_dwordx4 v[64:67], v1, s[36:39], s34 offen offset:0 sc1
    buffer_store_dwordx4 v[64:67], v1, s[36:39], s34 offen offset:1024 sc1
    buffer_store_dwordx4 v[64:67], v1, s[36:39], s34 offen offset:2048 sc1
    buffer_store_dwordx4 v[64:67], v1, s[36:39], s34 offen offset:3072 sc1
    s_waitcnt vmcnt(0)
    s_barrier
    s_mov_b64 exec, s[0:1]
    buffer_store_dword v118, v120, s[36:39], s2 offen sc1
    s_mov_b64 exec, -1
    s_and_b32 s60, s58, 15
    s_and_b32 s61, s58, 3
    s_lshl2_add_u32 s61, s56, s61
    s_cmp_lt_u32 s60, 8
    s_cbranch_scc1 W_SETO
    s_cmp_lt_u32 s60, 12
    s_cbranch_scc1 W_SETM
    s_cmp_ge_u32 s61, 28
    s_cbranch_scc1 FIN
    s_mov_b64 s[40:41], s[18:19]
    s_mov_b32 s42, 1835008
    s_movk_i32 s62, 3584
    s_lshl_b32 s32, s61, 7
    s_branch W_LOAD
W_SETM:
    s_mov_b64 s[40:41], s[24:25]
    s_mov_b32 s42, 3145728
    s_movk_i32 s62, 6144
    s_lshl_b32 s32, s61, 7
    s_add_u32 s32, s32, 2048
    s_branch W_LOAD
W_SETO:
    s_mov_b64 s[40:41], s[14:15]
    s_mov_b32 s42, 4194304
    s_movk_i32 s62, 1024
    s_lshl_b32 s32, s56, 19
    s_lshl_b32 s33, s60, 7
    s_add_u32 s32, s32, s33
W_LOAD:
    s_lshl_b32 s33, s3, 7
    s_mul_i32 s33, s33, s62
    s_add_u32 s32, s32, s33
    s_lshl_b32 s33, s62, 3
    s_sub_u32 s33, s33, 1024
    s_add_u32 s63, s33, 4096
    s_lshl_b32 s34, s3, 14
    v_lshrrev_b32 v4, 3, v0
    v_mul_lo_u32 v4, v4, s62
    v_and_b32 v5, 1, v2
    v_lshlrev_b32 v5, 1, v5
    v_and_b32 v6, 7, v0
    v_xor_b32 v5, v5, v6
    v_lshl_add_u32 v6, v5, 4, v4
    v_xor_b32 v5, 4, v5
    v_lshl_add_u32 v7, v5, 4, v4
    s_add_u32 m0, s34, 65536
    s_nop 0
    buffer_load_dwordx4 v6, s[40:43], s32 offen offset:0 nt lds
    s_add_u32 s32, s32, s33
    buffer_load_dwordx4 v7, s[40:43], s32 offen offset:1024 nt lds
    s_add_u32 s32, s32, s33
    buffer_load_dwordx4 v6, s[40:43], s32 offen offset:2048 nt lds
    s_add_u32 s32, s32, s33
    buffer_load_dwordx4 v7, s[40:43], s32 offen offset:3072 nt lds
    s_add_u32 s32, s32, s63
    s_add_u32 m0, s34, 69632
    s_nop 0
    buffer_load_dwordx4 v6, s[40:43], s32 offen offset:0 nt lds
    s_add_u32 s32, s32, s33
    buffer_load_dwordx4 v7, s[40:43], s32 offen offset:1024 nt lds
    s_add_u32 s32, s32, s33
    buffer_load_dwordx4 v6, s[40:43], s32 offen offset:2048 nt lds
    s_add_u32 s32, s32, s33
    buffer_load_dwordx4 v7, s[40:43], s32 offen offset:3072 nt lds
    s_add_u32 s32, s32, s63
    s_add_u32 m0, s34, 73728
    s_nop 0
    buffer_load_dwordx4 v6, s[40:43], s32 offen offset:0 nt lds
    s_add_u32 s32, s32, s33
    buffer_load_dwordx4 v7, s[40:43], s32 offen offset:1024 nt lds
    s_add_u32 s32, s32, s33
    buffer_load_dwordx4 v6, s[40:43], s32 offen offset:2048 nt lds
    s_add_u32 s32, s32, s33
    buffer_load_dwordx4 v7, s[40:43], s32 offen offset:3072 nt lds
    s_add_u32 s32, s32, s63
    s_add_u32 m0, s34, 77824
    s_nop 0
    buffer_load_dwordx4 v6, s[40:43], s32 offen offset:0 nt lds
    s_add_u32 s32, s32, s33
    buffer_load_dwordx4 v7, s[40:43], s32 offen offset:1024 nt lds
    s_add_u32 s32, s32, s33
    buffer_load_dwordx4 v6, s[40:43], s32 offen offset:2048 nt lds
    s_add_u32 s32, s32, s33
    buffer_load_dwordx4 v7, s[40:43], s32 offen offset:3072 nt lds
    v_bfe_u32 v4, v0, 2, 2
    v_lshl_add_u32 v5, v2, 3, v4
    v_lshlrev_b32 v5, 7, v5
    v_bfe_u32 v6, v0, 3, 2
    v_xor_b32 v6, s3, v6
    v_lshl_add_u32 v5, v6, 5, v5
    v_and_b32 v6, 3, v0
    v_lshl_add_u32 v5, v6, 3, v5
    v_add_u32 v10, 65536, v5
    s_cmp_lt_u32 s60, 8
    s_cbranch_scc1 W_WAIT
    s_cmp_lt_u32 s60, 12
    s_cbranch_scc1 W_PREM
    s_mov_b64 s[44:45], s[20:21]
    s_mov_b32 s46, 1835008
    s_lshl_b32 s32, s61, 16
    s_add_u32 s32, s32, s34
    v_xor_b32 v5, 16, v1
    v_xor_b32 v6, 32, v1
    v_xor_b32 v7, 48, v1
    s_add_u32 m0, s34, 0
    s_nop 0
    buffer_load_dwordx4 v1, s[44:47], s32 offen offset:0 nt lds
    buffer_load_dwordx4 v5, s[44:47], s32 offen offset:1024 nt lds
    buffer_load_dwordx4 v6, s[44:47], s32 offen offset:2048 nt lds
    buffer_load_dwordx4 v7, s[44:47], s32 offen offset:3072 nt lds
    s_add_u32 m0, s34, 4096
    s_add_u32 s32, s32, 4096
    buffer_load_dwordx4 v1, s[44:47], s32 offen offset:0 nt lds
    buffer_load_dwordx4 v5, s[44:47], s32 offen offset:1024 nt lds
    buffer_load_dwordx4 v6, s[44:47], s32 offen offset:2048 nt lds
    buffer_load_dwordx4 v7, s[44:47], s32 offen offset:3072 nt lds
    s_add_u32 m0, s34, 8192
    s_add_u32 s32, s32, 4096
    buffer_load_dwordx4 v1, s[44:47], s32 offen offset:0 nt lds
    buffer_load_dwordx4 v5, s[44:47], s32 offen offset:1024 nt lds
    buffer_load_dwordx4 v6, s[44:47], s32 offen offset:2048 nt lds
    buffer_load_dwordx4 v7, s[44:47], s32 offen offset:3072 nt lds
    s_add_u32 m0, s34, 12288
    s_add_u32 s32, s32, 4096
    buffer_load_dwordx4 v1, s[44:47], s32 offen offset:0 nt lds
    buffer_load_dwordx4 v5, s[44:47], s32 offen offset:1024 nt lds
    buffer_load_dwordx4 v6, s[44:47], s32 offen offset:2048 nt lds
    buffer_load_dwordx4 v7, s[44:47], s32 offen offset:3072 nt lds
    s_branch W_WAIT
W_PREM:
    s_mov_b64 s[48:49], s[22:23]
    s_mov_b32 s50, 2048
    s_lshl_b32 s32, s3, 9
    v_lshlrev_b32 v4, 3, v0
    buffer_load_dwordx2 v[16:17], v4, s[48:51], s32 offen
    s_lshr_b32 s33, s3, 1
    s_lshl_b32 s33, s33, 5
    s_add_u32 s32, s32, s33
    s_add_u32 s32, s32, 139264
    v_add_u32 v4, s32, v4
    s_waitcnt vmcnt(0)
    v_lshlrev_b32 v20, 16, v16
    v_and_b32 v21, 0xffff0000, v16
    v_lshlrev_b32 v22, 16, v17
    v_and_b32 v23, 0xffff0000, v17
    v_mul_f32 v24, 0xbfb8aa3b, v20
    v_mul_f32 v25, 0xbfb8aa3b, v21
    v_mul_f32 v26, 0xbfb8aa3b, v22
    v_mul_f32 v27, 0xbfb8aa3b, v23
    v_exp_f32 v24, v24
    v_exp_f32 v25, v25
    v_exp_f32 v26, v26
    v_exp_f32 v27, v27
    v_add_f32 v24, 1.0, v24
    v_add_f32 v25, 1.0, v25
    v_add_f32 v26, 1.0, v26
    v_add_f32 v27, 1.0, v27
    v_rcp_f32 v24, v24
    v_rcp_f32 v25, v25
    v_rcp_f32 v26, v26
    v_rcp_f32 v27, v27
    v_mul_f32 v20, v20, v24
    v_mul_f32 v21, v21, v25
    v_mul_f32 v22, v22, v26
    v_mul_f32 v23, v23, v27
    v_cvt_pk_bf16_f32 v16, v20, v21
    v_cvt_pk_bf16_f32 v17, v22, v23
    ds_write_b64 v4, v[16:17]
W_WAIT:
    s_waitcnt vmcnt(0) lgkmcnt(0)
    s_barrier
    ds_read_b64_tr_b16 a[0:1], v10 offset:0
    ds_read_b64_tr_b16 a[2:3], v10 offset:512
    ds_read_b64_tr_b16 a[4:5], v10 offset:4096
    ds_read_b64_tr_b16 a[6:7], v10 offset:4608
    ds_read_b64_tr_b16 a[8:9], v10 offset:8192
    ds_read_b64_tr_b16 a[10:11], v10 offset:8704
    ds_read_b64_tr_b16 a[12:13], v10 offset:12288
    ds_read_b64_tr_b16 a[14:15], v10 offset:12800
    ds_read_b64_tr_b16 a[16:17], v10 offset:16384
    ds_read_b64_tr_b16 a[18:19], v10 offset:16896
    ds_read_b64_tr_b16 a[20:21], v10 offset:20480
    ds_read_b64_tr_b16 a[22:23], v10 offset:20992
    ds_read_b64_tr_b16 a[24:25], v10 offset:24576
    ds_read_b64_tr_b16 a[26:27], v10 offset:25088
    ds_read_b64_tr_b16 a[28:29], v10 offset:28672
    ds_read_b64_tr_b16 a[30:31], v10 offset:29184
    ds_read_b64_tr_b16 a[32:33], v10 offset:32768
    ds_read_b64_tr_b16 a[34:35], v10 offset:33280
    ds_read_b64_tr_b16 a[36:37], v10 offset:36864
    ds_read_b64_tr_b16 a[38:39], v10 offset:37376
    ds_read_b64_tr_b16 a[40:41], v10 offset:40960
    ds_read_b64_tr_b16 a[42:43], v10 offset:41472
    ds_read_b64_tr_b16 a[44:45], v10 offset:45056
    ds_read_b64_tr_b16 a[46:47], v10 offset:45568
    ds_read_b64_tr_b16 a[48:49], v10 offset:49152
    ds_read_b64_tr_b16 a[50:51], v10 offset:49664
    ds_read_b64_tr_b16 a[52:53], v10 offset:53248
    ds_read_b64_tr_b16 a[54:55], v10 offset:53760
    ds_read_b64_tr_b16 a[56:57], v10 offset:57344
    ds_read_b64_tr_b16 a[58:59], v10 offset:57856
    ds_read_b64_tr_b16 a[60:61], v10 offset:61440
    ds_read_b64_tr_b16 a[62:63], v10 offset:61952
    s_cmp_lt_u32 s60, 8
    s_cbranch_scc0 W_NOTO
    s_lshl2_add_u32 s34, s56, s3
    s_lshl_b32 s34, s34, 11
    s_add_u32 s34, s34, 458752
    v_lshrrev_b32 v4, 5, v0
    v_bfe_u32 v5, v0, 2, 2
    v_lshl_add_u32 v4, v4, 2, v5
    v_and_b32 v5, 1, v2
    v_lshl_add_u32 v4, v4, 1, v5
    v_and_b32 v5, 3, v0
    v_lshl_add_u32 v4, v4, 2, v5
    v_lshlrev_b32 v16, 4, v4
    v_and_b32 v4, 1, v2
    v_lshlrev_b32 v4, 3, v4
    v_lshrrev_b32 v5, 1, v2
    v_or_b32 v4, v4, v5
    v_lshlrev_b32 v4, 4, v4
    v_xor_b32 v4, v4, v1
    s_lshl_b32 s32, s3, 11
    s_add_u32 s32, s32, 139264
    v_add_u32 v11, s32, v4
    v_xor_b32 v12, 32, v11
    v_and_b32 v4, 3, v0
    v_bfe_u32 v5, v0, 2, 1
    v_lshl_add_u32 v6, v4, 1, v5
    v_lshlrev_b32 v6, 8, v6
    v_xor_b32 v4, v4, v2
    v_lshl_add_u32 v6, v4, 4, v6
    v_lshl_add_u32 v6, v5, 7, v6
    v_bfe_u32 v4, v0, 3, 1
    v_lshl_add_u32 v6, v4, 6, v6
    v_add_u32 v13, 139264, v6
    v_xor_b32 v14, 128, v13
    v_lshlrev_b32 v5, 5, v5
    v_lshl_add_u32 v15, v2, 3, v5
    v_and_b32 v4, 3, v0
    v_lshl_add_u32 v15, v4, 15, v15
    s_lshl_b32 s35, s56, 11
    s_lshl2_add_u32 s32, s60, s3
    s_lshl_b32 s32, s32, 6
    s_add_u32 s35, s35, s32
    s_add_u32 s35, s35, 589824
    s_mov_b32 s96, 0x110011
    s_mov_b32 s97, 0x110011
    buffer_load_dwordx4 v[80:83], v16, s[36:39], s34 offen offset:0 sc1
    buffer_load_dwordx4 v[84:87], v16, s[36:39], s34 offen offset:1024 sc1
    s_movk_i32 s57, 20000
    s_branch MPC_11
MPL_10:
    s_sub_u32 s57, s57, 1
    s_cbranch_scc1 MPK_12
    s_mov_b64 exec, s[4:5]
    buffer_load_dwordx4 v[80:83], v16, s[36:39], s34 offen offset:0 sc1
    s_mov_b64 exec, s[6:7]
    buffer_load_dwordx4 v[84:87], v16, s[36:39], s34 offen offset:1024 sc1
    s_mov_b64 exec, -1
MPC_11:
    s_waitcnt vmcnt(0)
    v_cmp_eq_u32 s[4:5], -1, v80
    v_cmp_eq_u32 s[6:7], -1, v84
    s_or_b64 vcc, s[4:5], s[6:7]
    s_cbranch_scc1 MPL_10
MPK_12:
    ds_write_b128 v11, v[80:83]
    ds_write_b128 v12, v[84:87] offset:1024
    s_waitcnt lgkmcnt(0)
    s_barrier
    ds_read_b128 v[128:131], v13 offset:0
    ds_read_b128 v[132:135], v14 offset:0
    ds_read_b128 v[136:139], v13 offset:2048
    ds_read_b128 v[140:143], v14 offset:2048
    ds_read_b128 v[144:147], v13 offset:4096
    ds_read_b128 v[148:151], v14 offset:4096
    ds_read_b128 v[152:155], v13 offset:6144
    ds_read_b128 v[156:159], v14 offset:6144
    s_waitcnt lgkmcnt(7)
    v_mfma_f32_16x16x32_bf16 v[104:107], a[0:3], v[128:131], 0
    v_mfma_f32_16x16x32_bf16 v[108:111], a[4:7], v[128:131], 0
    s_waitcnt lgkmcnt(6)
    v_mfma_f32_16x16x32_bf16 v[104:107], a[8:11], v[132:135], v[104:107]
    v_mfma_f32_16x16x32_bf16 v[108:111], a[12:15], v[132:135], v[108:111]
    s_waitcnt lgkmcnt(5)
    v_mfma_f32_16x16x32_bf16 v[104:107], a[16:19], v[136:139], v[104:107]
    v_mfma_f32_16x16x32_bf16 v[108:111], a[20:23], v[136:139], v[108:111]
    s_waitcnt lgkmcnt(4)
    v_mfma_f32_16x16x32_bf16 v[104:107], a[24:27], v[140:143], v[104:107]
    v_mfma_f32_16x16x32_bf16 v[108:111], a[28:31], v[140:143], v[108:111]
    s_waitcnt lgkmcnt(3)
    v_mfma_f32_16x16x32_bf16 v[104:107], a[32:35], v[144:147], v[104:107]
    v_mfma_f32_16x16x32_bf16 v[108:111], a[36:39], v[144:147], v[108:111]
    s_waitcnt lgkmcnt(2)
    v_mfma_f32_16x16x32_bf16 v[104:107], a[40:43], v[148:151], v[104:107]
    v_mfma_f32_16x16x32_bf16 v[108:111], a[44:47], v[148:151], v[108:111]
    s_waitcnt lgkmcnt(1)
    v_mfma_f32_16x16x32_bf16 v[104:107], a[48:51], v[152:155], v[104:107]
    v_mfma_f32_16x16x32_bf16 v[108:111], a[52:55], v[152:155], v[108:111]
    s_waitcnt lgkmcnt(0)
    v_mfma_f32_16x16x32_bf16 v[104:107], a[56:59], v[156:159], v[104:107]
    v_mfma_f32_16x16x32_bf16 v[108:111], a[60:63], v[156:159], v[108:111]
    s_nop 7
    v_add_f32_dpp v112, v108, v104 row_ror:8 row_mask:0xf bank_mask:0xf
    v_add_f32_dpp v113, v109, v105 row_ror:8 row_mask:0xf bank_mask:0xf
    v_add_f32_dpp v114, v110, v106 row_ror:8 row_mask:0xf bank_mask:0xf
    v_add_f32_dpp v115, v111, v107 row_ror:8 row_mask:0xf bank_mask:0xf
    v_add_f32_dpp v112, v112, v112 quad_perm:[1,0,3,2] row_mask:0xf bank_mask:0xf
    v_add_f32_dpp v113, v113, v113 quad_perm:[1,0,3,2] row_mask:0xf bank_mask:0xf
    v_add_f32_dpp v114, v114, v114 quad_perm:[1,0,3,2] row_mask:0xf bank_mask:0xf
    v_add_f32_dpp v115, v115, v115 quad_perm:[1,0,3,2] row_mask:0xf bank_mask:0xf
    v_add_f32_dpp v112, v112, v112 quad_perm:[2,3,0,1] row_mask:0xf bank_mask:0xf
    v_add_f32_dpp v113, v113, v113 quad_perm:[2,3,0,1] row_mask:0xf bank_mask:0xf
    v_add_f32_dpp v114, v114, v114 quad_perm:[2,3,0,1] row_mask:0xf bank_mask:0xf
    v_add_f32_dpp v115, v115, v115 quad_perm:[2,3,0,1] row_mask:0xf bank_mask:0xf
    s_mov_b64 exec, s[96:97]
    v_cvt_pk_bf16_f32 v116, v112, v113
    v_cvt_pk_bf16_f32 v117, v114, v115
    buffer_store_dwordx2 v[116:117], v15, s[36:39], s35 offen sc1
    s_branch FIN
W_NOTO:
    v_and_b32 v4, 3, v0
    v_mul_u32_u24 v4, 2112, v4
    v_bfe_u32 v5, v0, 2, 1
    v_mul_u32_u24 v5, 1056, v5
    v_lshl_add_u32 v5, v2, 4, v5
    s_cmp_lt_u32 s60, 12
    s_cbranch_scc1 W_M2
    s_mov_b32 s32, 139264
    v_add3_u32 v11, v4, v5, s32
    v_bfe_u32 v4, v0, 2, 2
    v_lshl_add_u32 v5, v2, 3, v4
    v_lshlrev_b32 v5, 10, v5
    v_lshl_add_u32 v5, v4, 4, v5
    v_and_b32 v4, 3, v0
    v_lshl_add_u32 v5, v4, 6, v5
    s_lshl_b32 s33, s3, 8
    v_add_u32 v4, s33, v5
    ds_read_b64_tr_b16 a[64:65], v4 offset:0
    ds_read_b64_tr_b16 a[66:67], v4 offset:4096
    ds_read_b64_tr_b16 a[68:69], v4 offset:32768
    ds_read_b64_tr_b16 a[70:71], v4 offset:36864
    ds_read_b64_tr_b16 a[72:73], v4 offset:8
    ds_read_b64_tr_b16 a[74:75], v4 offset:4104
    ds_read_b64_tr_b16 a[76:77], v4 offset:32776
    ds_read_b64_tr_b16 a[78:79], v4 offset:36872
    v_xor_b32 v5, 16, v4
    ds_read_b64_tr_b16 a[80:81], v5 offset:0
    ds_read_b64_tr_b16 a[82:83], v5 offset:4096
    ds_read_b64_tr_b16 a[84:85], v5 offset:32768
    ds_read_b64_tr_b16 a[86:87], v5 offset:36864
    ds_read_b64_tr_b16 a[88:89], v5 offset:8
    ds_read_b64_tr_b16 a[90:91], v5 offset:4104
    ds_read_b64_tr_b16 a[92:93], v5 offset:32776
    ds_read_b64_tr_b16 a[94:95], v5 offset:36872
    v_xor_b32 v6, 32, v4
    ds_read_b64_tr_b16 a[96:97], v6 offset:0
    ds_read_b64_tr_b16 a[98:99], v6 offset:4096
    ds_read_b64_tr_b16 a[100:101], v6 offset:32768
    ds_read_b64_tr_b16 a[102:103], v6 offset:36864
    ds_read_b64_tr_b16 a[104:105], v6 offset:8
    ds_read_b64_tr_b16 a[106:107], v6 offset:4104
    ds_read_b64_tr_b16 a[108:109], v6 offset:32776
    ds_read_b64_tr_b16 a[110:111], v6 offset:36872
    v_xor_b32 v7, 48, v4
    ds_read_b64_tr_b16 a[112:113], v7 offset:0
    ds_read_b64_tr_b16 a[114:115], v7 offset:4096
    ds_read_b64_tr_b16 a[116:117], v7 offset:32768
    ds_read_b64_tr_b16 a[118:119], v7 offset:36864
    ds_read_b64_tr_b16 a[120:121], v7 offset:8
    ds_read_b64_tr_b16 a[122:123], v7 offset:4104
    ds_read_b64_tr_b16 a[124:125], v7 offset:32776
    ds_read_b64_tr_b16 a[126:127], v7 offset:36872
    s_mov_b64 s[44:45], s[4:5]
    s_mov_b32 s46, 2048
    v_lshrrev_b32 v4, 5, v0
    v_and_b32 v5, 1, v2
    v_lshl_add_u32 v6, v3, 1, v5
    v_lshlrev_b32 v7, 3, v6
    v_lshl_add_u32 v8, v4, 10, v7
    buffer_load_dwordx2 v[16:17], v8, s[44:47], s33 offen
    v_mul_u32_u24 v8, 1056, v4
    s_add_u32 s32, s33, 139264
    v_add3_u32 v12, v8, v7, s32
    v_lshlrev_b32 v7, 4, v6
    v_lshl_add_u32 v13, v4, 13, v7
    s_lshl_b32 s34, s3, 9
    s_add_u32 s34, s34, 606208
    s_add_u32 s35, s34, 4096
    v_and_b32 v6, 31, v0
    v_lshlrev_b32 v6, 3, v6
    v_lshl_add_u32 v6, v4, 10, v6
    s_add_u32 s32, s33, 149504
    v_add_u32 v14, s32, v6
    v_lshlrev_b32 v6, 4, v3
    v_lshl_add_u32 v6, v4, 8, v6
    v_lshl_add_u32 v6, v5, 10, v6
    v_add_u32 v15, 149504, v6
    v_lshrrev_b32 v6, 1, v3
    v_lshl_add_u32 v6, v4, 5, v6
    v_lshl_add_u32 v6, v6, 1, v5
    v_and_b32 v7, 1, v0
    v_lshl_add_u32 v6, v6, 1, v7
    v_lshlrev_b32 v26, 4, v6
    s_and_b32 s62, s56, 0
    s_lshl_b32 s62, s62, 13
    s_add_u32 s62, s62, s33
    s_lshl_b32 s62, s62, 1
    s_add_u32 s62, s62, 589824
    s_add_u32 s63, s62, 4096
    s_add_u32 s0, s62, 8192
    s_add_u32 s1, s62, 12288
    v_mul_u32_u24 v6, 160, v5
    v_lshl_add_u32 v6, v3, 1, v6
    s_lshl_b32 s32, s3, 5
    s_add_u32 s32, s32, 151552
    v_add_u32 v27, s32, v6
    v_bfe_u32 v6, v0, 2, 1
    v_mul_u32_u24 v6, 160, v6
    v_lshl_add_u32 v6, v2, 4, v6
    v_add_u32 v28, 151552, v6
    v_bfe_u32 v6, v0, 3, 1
    v_mul_u32_u24 v7, 7168, v6
    v_lshl_add_u32 v7, v5, 7, v7
    v_and_b32 v8, 7, v0
    v_lshl_add_u32 v29, v8, 4, v7
    v_xor_b32 v6, v6, v5
    s_mul_i32 s2, s3, 14336
    s_lshl_b32 s32, s61, 8
    s_add_u32 s2, s2, s32
    s_add_u32 s2, s2, 524288
    v_and_b32 v24, 1, v8
    v_lshlrev_b32 v24, 4, v24
    s_movk_i32 s32, 0x3f80
    v_lshlrev_b32 v24, v24, s32
    v_lshrrev_b32 v25, 1, v8
    v_lshl_or_b32 v25, v6, 2, v25
    v_cmp_eq_u32 vcc, 0, v25
    s_nop 1
    v_cndmask_b32 v20, 0, v24, vcc
    v_cmp_eq_u32 vcc, 1, v25
    s_nop 1
    v_cndmask_b32 v21, 0, v24, vcc
    v_cmp_eq_u32 vcc, 2, v25
    s_nop 1
    v_cndmask_b32 v22, 0, v24, vcc
    v_cmp_eq_u32 vcc, 3, v25
    s_nop 1
    v_cndmask_b32 v23, 0, v24, vcc
    s_movk_i32 s57, 20000
POLL_13:
    buffer_load_dwordx4 v[32:35], v13, s[36:39], s34 offen sc1
    buffer_load_dwordx4 v[36:39], v13, s[36:39], s34 offen offset:2048 sc1
    buffer_load_dwordx4 v[40:43], v13, s[36:39], s35 offen sc1
    s_waitcnt vmcnt(0)
    v_max_u32 v4, v32, v33
    v_max3_u32 v4, v4, v34, v35
    v_max3_u32 v4, v4, v36, v37
    v_max3_u32 v4, v4, v38, v39
    v_max3_u32 v4, v4, v40, v41
    v_max3_u32 v4, v4, v42, v43
    v_cmp_eq_u32 vcc, -1, v4
    s_cbranch_vccz POK_14
    s_sub_u32 s57, s57, 1
    s_cbranch_scc0 POLL_13
POK_14:
    v_add_f32 v40, 1.0, v40
    v_add_f32 v41, 1.0, v41
    v_add_f32 v42, 1.0, v42
    v_add_f32 v43, 1.0, v43
    v_cvt_pk_bf16_f32 v4, v40, v41
    v_cvt_pk_bf16_f32 v5, v42, v43
    v_cvt_pk_bf16_f32 v6, v36, v37
    v_cvt_pk_bf16_f32 v7, v38, v39
    ds_write_b64 v12, v[4:5] offset:2112
    ds_write_b64 v12, v[6:7] offset:4224
    v_lshlrev_b32 v40, 16, v4
    v_and_b32 v41, 0xffff0000, v4
    v_lshlrev_b32 v42, 16, v5
    v_and_b32 v43, 0xffff0000, v5
    v_lshlrev_b32 v36, 16, v16
    v_and_b32 v37, 0xffff0000, v16
    v_lshlrev_b32 v38, 16, v17
    v_and_b32 v39, 0xffff0000, v17
    buffer_load_dwordx4 v[48:51], v26, s[36:39], s62 offen sc1
    buffer_load_dwordx4 v[52:55], v26, s[36:39], s63 offen sc1
    buffer_load_dwordx4 v[56:59], v26, s[36:39], s0 offen sc1
    buffer_load_dwordx4 v[60:63], v26, s[36:39], s1 offen sc1
    s_movk_i32 s57, 20000
    s_branch MPC_16
MPL_15:
    s_sub_u32 s57, s57, 1
    s_cbranch_scc1 MPK_17
    s_mov_b64 exec, s[4:5]
    buffer_load_dwordx4 v[48:51], v26, s[36:39], s62 offen sc1
    s_mov_b64 exec, s[6:7]
    buffer_load_dwordx4 v[52:55], v26, s[36:39], s63 offen sc1
    s_mov_b64 exec, s[8:9]
    buffer_load_dwordx4 v[56:59], v26, s[36:39], s0 offen sc1
    s_mov_b64 exec, s[10:11]
    buffer_load_dwordx4 v[60:63], v26, s[36:39], s1 offen sc1
    s_mov_b64 exec, -1
MPC_16:
    s_waitcnt vmcnt(0)
    v_max_u32 v4, v48, v50
    v_cmp_eq_u32 s[4:5], -1, v4
    v_max_u32 v5, v52, v54
    v_cmp_eq_u32 s[6:7], -1, v5
    v_max_u32 v6, v56, v58
    v_cmp_eq_u32 s[8:9], -1, v6
    v_max_u32 v7, v60, v62
    v_cmp_eq_u32 s[10:11], -1, v7
    s_or_b64 vcc, s[4:5], s[10:11]
    s_or_b64 vcc, vcc, s[6:7]
    s_or_b64 vcc, vcc, s[8:9]
    s_cbranch_scc1 MPL_15
MPK_17:
    v_mfma_f32_16x16x32_bf16 v[44:47], v[20:23], v[48:51], 0
    v_mfma_f32_16x16x32_bf16 v[44:47], v[20:23], v[52:55], v[44:47]
    v_mfma_f32_16x16x32_bf16 v[44:47], v[20:23], v[56:59], v[44:47]
    v_mfma_f32_16x16x32_bf16 v[44:47], v[20:23], v[60:63], v[44:47]
    s_nop 7
    v_pk_fma_f32 v[36:37], v[32:33], v[44:45], v[36:37]
    v_pk_fma_f32 v[38:39], v[34:35], v[46:47], v[38:39]
    v_pk_mul_f32 v[40:41], v[40:41], v[36:37]
    v_pk_mul_f32 v[42:43], v[42:43], v[38:39]
    v_cvt_pk_bf16_f32 v4, v40, v41
    v_cvt_pk_bf16_f32 v5, v42, v43
    ds_write_b64 v12, v[4:5]
    v_pk_add_f32 v[6:7], v[36:37], v[38:39]
    v_pk_mul_f32 v[8:9], v[36:37], v[36:37]
    v_pk_fma_f32 v[8:9], v[38:39], v[38:39], v[8:9]
    v_add_f32 v6, v6, v7
    v_add_f32 v7, v8, v9
    ds_write_b64 v14, v[6:7]
    s_waitcnt lgkmcnt(0)
    s_barrier
    ds_read_b128 v[32:35], v15
    ds_read_b128 v[36:39], v15 offset:512
    ds_read_b128 v[128:131], v11 offset:0
    ds_read_b128 v[132:135], v11 offset:64
    ds_read_b128 v[136:139], v11 offset:128
    ds_read_b128 v[140:143], v11 offset:192
    ds_read_b128 v[144:147], v11 offset:256
    ds_read_b128 v[148:151], v11 offset:320
    ds_read_b128 v[152:155], v11 offset:384
    ds_read_b128 v[156:159], v11 offset:448
    ds_read_b128 v[160:163], v11 offset:512
    ds_read_b128 v[164:167], v11 offset:576
    ds_read_b128 v[168:171], v11 offset:640
    ds_read_b128 v[172:175], v11 offset:704
    s_waitcnt lgkmcnt(11)
    v_mfma_f32_16x16x32_bf16 v[104:107], v[128:131], a[0:3], 0
    ds_read_b128 v[176:179], v11 offset:768
    v_pk_add_f32 v[32:33], v[32:33], v[34:35]
    v_pk_add_f32 v[36:37], v[36:37], v[38:39]
    v_pk_add_f32 v[32:33], v[32:33], v[36:37]
    s_waitcnt lgkmcnt(11)
    v_mfma_f32_16x16x32_bf16 v[108:111], v[132:135], a[4:7], 0
    ds_read_b128 v[180:183], v11 offset:832
    v_add_f32_dpp v32, v32, v32 quad_perm:[1,0,3,2] row_mask:0xf bank_mask:0xf
    v_add_f32_dpp v33, v33, v33 quad_perm:[1,0,3,2] row_mask:0xf bank_mask:0xf
    s_nop 0
    s_waitcnt lgkmcnt(11)
    v_mfma_f32_16x16x32_bf16 v[104:107], v[136:139], a[8:11], v[104:107]
    ds_read_b128 v[184:187], v11 offset:896
    v_add_f32_dpp v32, v32, v32 quad_perm:[2,3,0,1] row_mask:0xf bank_mask:0xf
    v_add_f32_dpp v33, v33, v33 quad_perm:[2,3,0,1] row_mask:0xf bank_mask:0xf
    s_nop 0
    s_waitcnt lgkmcnt(11)
    v_mfma_f32_16x16x32_bf16 v[108:111], v[140:143], a[12:15], v[108:111]
    ds_read_b128 v[188:191], v11 offset:960
    v_add_f32_dpp v32, v32, v32 row_half_mirror row_mask:0xf bank_mask:0xf
    v_add_f32_dpp v33, v33, v33 row_half_mirror row_mask:0xf bank_mask:0xf
    s_nop 0
    s_waitcnt lgkmcnt(11)
    v_mfma_f32_16x16x32_bf16 v[104:107], v[144:147], a[16:19], v[104:107]
    v_add_f32_dpp v32, v32, v32 row_mirror row_mask:0xf bank_mask:0xf
    v_add_f32_dpp v33, v33, v33 row_mirror row_mask:0xf bank_mask:0xf
    s_nop 0
    s_waitcnt lgkmcnt(10)
    v_mfma_f32_16x16x32_bf16 v[108:111], v[148:151], a[20:23], v[108:111]
    v_mov_b32 v34, v32
    v_mov_b32 v35, v33
    s_nop 0
    s_waitcnt lgkmcnt(9)
    v_mfma_f32_16x16x32_bf16 v[104:107], v[152:155], a[24:27], v[104:107]
    v_permlane32_swap_b32 v32, v34
    v_permlane32_swap_b32 v33, v35
    s_nop 0
    s_waitcnt lgkmcnt(8)
    v_mfma_f32_16x16x32_bf16 v[108:111], v[156:159], a[28:31], v[108:111]
    v_pk_add_f32 v[32:33], v[32:33], v[34:35]
    v_mov_b32 v34, 0x3727c5ac
    v_mul_f32 v32, 0x3b000000, v32
    s_waitcnt lgkmcnt(7)
    v_mfma_f32_16x16x32_bf16 v[104:107], v[160:163], a[32:35], v[104:107]
    v_fmac_f32 v34, 0x3b000000, v33
    v_fma_f32 v34, -v32, v32, v34
    v_rsq_f32 v34, v34
    s_waitcnt lgkmcnt(6)
    v_mfma_f32_16x16x32_bf16 v[108:111], v[164:167], a[36:39], v[108:111]
    s_waitcnt lgkmcnt(5)
    v_mfma_f32_16x16x32_bf16 v[104:107], v[168:171], a[40:43], v[104:107]
    s_waitcnt lgkmcnt(4)
    v_mfma_f32_16x16x32_bf16 v[108:111], v[172:175], a[44:47], v[108:111]
    s_waitcnt lgkmcnt(3)
    v_mfma_f32_16x16x32_bf16 v[104:107], v[176:179], a[48:51], v[104:107]
    s_waitcnt lgkmcnt(2)
    v_mfma_f32_16x16x32_bf16 v[108:111], v[180:183], a[52:55], v[108:111]
    s_waitcnt lgkmcnt(1)
    v_mfma_f32_16x16x32_bf16 v[104:107], v[184:187], a[56:59], v[104:107]
    s_waitcnt lgkmcnt(0)
    v_mfma_f32_16x16x32_bf16 v[108:111], v[188:191], a[60:63], v[108:111]
    s_mov_b32 exec_hi, 0
    s_nop 6
    v_pk_add_f32 v[104:105], v[104:105], v[108:109]
    v_add_f32 v106, v106, v110
    v_fma_f32 v104, -v32, v105, v104
    v_fma_f32 v104, v34, v104, v106
    v_max_f32 v104, 0, v104
    v_cvt_pk_bf16_f32 v104, v104, v104
    ds_write_b16 v27, v104
    s_mov_b32 exec_hi, -1
    s_waitcnt lgkmcnt(0)
    s_barrier
    ds_read_b128 v[32:35], v28
    ds_read_b128 v[36:39], v28 offset:64
    s_waitcnt lgkmcnt(1)
    v_mfma_f32_16x16x32_bf16 v[128:131], v[32:35], a[64:67], 0
    v_mfma_f32_16x16x32_bf16 v[132:135], v[32:35], a[72:75], 0
    v_mfma_f32_16x16x32_bf16 v[136:139], v[32:35], a[80:83], 0
    v_mfma_f32_16x16x32_bf16 v[140:143], v[32:35], a[88:91], 0
    v_mfma_f32_16x16x32_bf16 v[144:147], v[32:35], a[96:99], 0
    v_mfma_f32_16x16x32_bf16 v[148:151], v[32:35], a[104:107], 0
    v_mfma_f32_16x16x32_bf16 v[152:155], v[32:35], a[112:115], 0
    v_mfma_f32_16x16x32_bf16 v[156:159], v[32:35], a[120:123], 0
    s_waitcnt lgkmcnt(0)
    v_mfma_f32_16x16x32_bf16 v[128:131], v[36:39], a[68:71], v[128:131]
    v_mfma_f32_16x16x32_bf16 v[132:135], v[36:39], a[76:79], v[132:135]
    v_mfma_f32_16x16x32_bf16 v[136:139], v[36:39], a[84:87], v[136:139]
    v_mfma_f32_16x16x32_bf16 v[140:143], v[36:39], a[92:95], v[140:143]
    v_mfma_f32_16x16x32_bf16 v[144:147], v[36:39], a[100:103], v[144:147]
    v_mfma_f32_16x16x32_bf16 v[148:151], v[36:39], a[108:111], v[148:151]
    v_mfma_f32_16x16x32_bf16 v[152:155], v[36:39], a[116:119], v[152:155]
    v_mfma_f32_16x16x32_bf16 v[156:159], v[36:39], a[124:127], v[156:159]
    s_mov_b32 exec_hi, 0
    s_nop 0
    v_cvt_pk_bf16_f32 v40, v128, v132
    s_nop 0
    v_cvt_pk_bf16_f32 v41, v136, v140
    s_nop 0
    v_cvt_pk_bf16_f32 v42, v144, v148
    s_nop 0
    v_cvt_pk_bf16_f32 v43, v152, v156
    buffer_store_dwordx4 v[40:43], v29, s[36:39], s2 offen sc1
    s_branch FIN
W_M2:
    v_add_u32 v11, 139264, v5
    v_lshlrev_b32 v4, 2, v3
    v_lshl_add_u32 v12, v2, 13, v4
    s_lshl2_add_u32 s34, s61, s3
    s_lshl_b32 s34, s34, 6
    s_add_u32 s34, s34, 606208
    s_waitcnt lgkmcnt(0)
    ds_read_b128 v[128:131], v11 offset:0
    ds_read_b128 v[132:135], v11 offset:64
    ds_read_b128 v[136:139], v11 offset:128
    ds_read_b128 v[140:143], v11 offset:192
    ds_read_b128 v[144:147], v11 offset:256
    ds_read_b128 v[148:151], v11 offset:320
    ds_read_b128 v[152:155], v11 offset:384
    ds_read_b128 v[156:159], v11 offset:448
    ds_read_b128 v[160:163], v11 offset:512
    ds_read_b128 v[164:167], v11 offset:576
    ds_read_b128 v[168:171], v11 offset:640
    ds_read_b128 v[172:175], v11 offset:704
    s_waitcnt lgkmcnt(11)
    v_mfma_f32_16x16x32_bf16 v[104:107], v[128:131], a[0:3], 0
    ds_read_b128 v[176:179], v11 offset:768
    s_waitcnt lgkmcnt(11)
    v_mfma_f32_16x16x32_bf16 v[108:111], v[132:135], a[4:7], 0
    ds_read_b128 v[180:183], v11 offset:832
    s_waitcnt lgkmcnt(11)
    v_mfma_f32_16x16x32_bf16 v[104:107], v[136:139], a[8:11], v[104:107]
    ds_read_b128 v[184:187], v11 offset:896
    s_waitcnt lgkmcnt(11)
    v_mfma_f32_16x16x32_bf16 v[108:111], v[140:143], a[12:15], v[108:111]
    ds_read_b128 v[188:191], v11 offset:960
    s_waitcnt lgkmcnt(11)
    v_mfma_f32_16x16x32_bf16 v[104:107], v[144:147], a[16:19], v[104:107]
    s_waitcnt lgkmcnt(10)
    v_mfma_f32_16x16x32_bf16 v[108:111], v[148:151], a[20:23], v[108:111]
    s_waitcnt lgkmcnt(9)
    v_mfma_f32_16x16x32_bf16 v[104:107], v[152:155], a[24:27], v[104:107]
    s_waitcnt lgkmcnt(8)
    v_mfma_f32_16x16x32_bf16 v[108:111], v[156:159], a[28:31], v[108:111]
    s_waitcnt lgkmcnt(7)
    v_mfma_f32_16x16x32_bf16 v[104:107], v[160:163], a[32:35], v[104:107]
    s_waitcnt lgkmcnt(6)
    v_mfma_f32_16x16x32_bf16 v[108:111], v[164:167], a[36:39], v[108:111]
    s_waitcnt lgkmcnt(5)
    v_mfma_f32_16x16x32_bf16 v[104:107], v[168:171], a[40:43], v[104:107]
    s_waitcnt lgkmcnt(4)
    v_mfma_f32_16x16x32_bf16 v[108:111], v[172:175], a[44:47], v[108:111]
    s_waitcnt lgkmcnt(3)
    v_mfma_f32_16x16x32_bf16 v[104:107], v[176:179], a[48:51], v[104:107]
    s_waitcnt lgkmcnt(2)
    v_mfma_f32_16x16x32_bf16 v[108:111], v[180:183], a[52:55], v[108:111]
    s_waitcnt lgkmcnt(1)
    v_mfma_f32_16x16x32_bf16 v[104:107], v[184:187], a[56:59], v[104:107]
    s_waitcnt lgkmcnt(0)
    v_mfma_f32_16x16x32_bf16 v[108:111], v[188:191], a[60:63], v[108:111]
    s_mov_b32 exec_hi, 0
    s_nop 6
    v_add_f32 v104, v104, v108
    v_cvt_pk_bf16_f32 v104, v104, v104
    v_lshlrev_b32 v104, 16, v104
    buffer_store_dword v104, v12, s[36:39], s34 offen sc1
    s_mov_b32 exec_hi, -1
    s_cmp_lt_u32 s61, 24
    s_cbranch_scc1 FIN
    s_cmp_lg_u32 s3, 0
    s_cbranch_scc1 FIN
    s_sub_u32 s61, s61, 24
    s_mov_b64 s[44:45], s[4:5]
    s_mov_b32 s46, 2048
    s_mov_b64 s[48:49], s[26:27]
    s_mov_b32 s50, 2048
    v_bfe_u32 v4, v0, 3, 1
    v_and_b32 v5, 7, v0
    v_lshl_add_u32 v6, v5, 2, v2
    v_lshlrev_b32 v7, 2, v6
    v_lshl_add_u32 v7, v4, 10, v7
    s_lshl_b32 s33, s61, 7
    buffer_load_dword v16, v7, s[44:47], s33 offen
    v_lshlrev_b32 v7, 3, v6
    v_lshl_add_u32 v11, v4, 13, v7
    v_lshl_add_u32 v7, v4, 8, v7
    v_add_u32 v12, 152064, v7
    v_bfe_u32 v6, v0, 2, 1
    v_lshl_add_u32 v6, v6, 2, v2
    v_and_b32 v7, 3, v0
    v_lshl_add_u32 v6, v6, 3, v7
    v_lshlrev_b32 v8, 2, v6
    v_lshl_add_u32 v13, v4, 13, v8
    v_lshl_add_u32 v8, v4, 8, v8
    v_add_u32 v14, 152064, v8
    v_lshlrev_b32 v8, 1, v6
    v_lshl_add_u32 v15, v4, 10, v8
    v_lshrrev_b32 v8, 1, v5
    v_lshl_add_u32 v8, v2, 5, v8
    v_lshl_add_u32 v8, v8, 1, v4
    v_and_b32 v26, 1, v0
    v_lshl_add_u32 v8, v8, 1, v26
    v_lshlrev_b32 v26, 4, v8
    s_lshl_b32 s34, s61, 8
    s_add_u32 s34, s34, 606208
    s_add_u32 s35, s34, 6144
    s_and_b32 s62, s56, 0
    s_lshl_b32 s62, s62, 13
    s_add_u32 s62, s62, s33
    s_lshl_b32 s62, s62, 1
    s_add_u32 s62, s62, 589824
    s_add_u32 s63, s62, 8192
    s_mul_i32 s0, s61, 7168
    s_add_u32 s0, s0, 524288
    s_add_u32 s1, s0, 4096
    v_bfe_u32 v8, v0, 2, 2
    v_and_b32 v6, 1, v0
    v_lshl_add_u32 v8, v8, 1, v6
    v_bfe_u32 v6, v0, 1, 1
    v_and_b32 v24, 1, v8
    v_lshlrev_b32 v24, 4, v24
    s_movk_i32 s32, 0x3f80
    v_lshlrev_b32 v24, v24, s32
    v_lshrrev_b32 v25, 1, v8
    v_lshl_or_b32 v25, v6, 2, v25
    v_cmp_eq_u32 vcc, 0, v25
    s_nop 1
    v_cndmask_b32 v20, 0, v24, vcc
    v_cmp_eq_u32 vcc, 1, v25
    s_nop 1
    v_cndmask_b32 v21, 0, v24, vcc
    v_cmp_eq_u32 vcc, 2, v25
    s_nop 1
    v_cndmask_b32 v22, 0, v24, vcc
    v_cmp_eq_u32 vcc, 3, v25
    s_nop 1
    v_cndmask_b32 v23, 0, v24, vcc
    s_movk_i32 s57, 20000
POLL_18:
    buffer_load_dwordx2 v[32:33], v11, s[36:39], s34 offen sc1
    buffer_load_dword v34, v13, s[36:39], s35 offen sc1
    buffer_load_dword v35, v13, s[36:39], s35 offen offset:16 sc1
    s_waitcnt vmcnt(0)
    v_max_u32 v4, v32, v33
    v_max3_u32 v4, v4, v34, v35
    v_cmp_eq_u32 vcc, -1, v4
    s_cbranch_vccz POK_19
    s_sub_u32 s57, s57, 1
    s_cbranch_scc0 POLL_18
POK_19:
    v_lshlrev_b32 v36, 16, v16
    v_and_b32 v37, 0xffff0000, v16
    buffer_load_dwordx4 v[48:51], v26, s[36:39], s62 offen sc1
    buffer_load_dwordx4 v[52:55], v26, s[36:39], s63 offen sc1
    s_movk_i32 s57, 20000
    s_branch MPC_21
MPL_20:
    s_sub_u32 s57, s57, 1
    s_cbranch_scc1 MPK_22
    s_mov_b64 exec, s[4:5]
    buffer_load_dwordx4 v[48:51], v26, s[36:39], s62 offen sc1
    s_mov_b64 exec, s[6:7]
    buffer_load_dwordx4 v[52:55], v26, s[36:39], s63 offen sc1
    s_mov_b64 exec, -1
MPC_21:
    s_waitcnt vmcnt(0)
    v_max_u32 v4, v48, v50
    v_cmp_eq_u32 s[4:5], -1, v4
    v_max_u32 v5, v52, v54
    v_cmp_eq_u32 s[6:7], -1, v5
    s_or_b64 vcc, s[4:5], s[6:7]
    s_cbranch_scc1 MPL_20
MPK_22:
    v_mfma_f32_16x16x32_bf16 v[44:47], v[20:23], v[48:51], 0
    v_mfma_f32_16x16x32_bf16 v[44:47], v[20:23], v[52:55], v[44:47]
    s_nop 7
    v_pk_fma_f32 v[36:37], v[32:33], v[44:45], v[36:37]
    ds_write_b64 v12, v[36:37]
    s_waitcnt lgkmcnt(0)
    ds_read_b32 v36, v14
    ds_read_b32 v37, v14 offset:16
    s_cmp_lg_u32 s61, 0
    s_cbranch_scc1 W_NOGEN
    s_mov_b64 exec, 1
    buffer_store_dword v118, v0, s[36:39], 0 offen sc1
    s_mov_b64 exec, -1
W_NOGEN:
    buffer_load_dwordx4 v[48:51], v1, s[36:39], s0 offen offset:0 sc1
    buffer_load_dwordx4 v[52:55], v1, s[36:39], s0 offen offset:1024 sc1
    buffer_load_dwordx4 v[56:59], v1, s[36:39], s0 offen offset:2048 sc1
    buffer_load_dwordx4 v[60:63], v1, s[36:39], s0 offen offset:3072 sc1
    buffer_load_dwordx4 v[64:67], v1, s[36:39], s1 offen offset:0 sc1
    buffer_load_dwordx4 v[68:71], v1, s[36:39], s1 offen offset:1024 sc1
    buffer_load_dwordx4 v[72:75], v1, s[36:39], s1 offen offset:2048 sc1
    buffer_load_dwordx4 v[48:51], v1, s[36:39], s0 offen offset:0 sc1
    buffer_load_dwordx4 v[52:55], v1, s[36:39], s0 offen offset:1024 sc1
    buffer_load_dwordx4 v[56:59], v1, s[36:39], s0 offen offset:2048 sc1
    buffer_load_dwordx4 v[60:63], v1, s[36:39], s0 offen offset:3072 sc1
    buffer_load_dwordx4 v[64:67], v1, s[36:39], s1 offen offset:0 sc1
    buffer_load_dwordx4 v[68:71], v1, s[36:39], s1 offen offset:1024 sc1
    buffer_load_dwordx4 v[72:75], v1, s[36:39], s1 offen offset:2048 sc1
    s_movk_i32 s57, 20000
POLL_23:
    buffer_load_dwordx4 v[48:51], v1, s[36:39], s0 offen offset:0 sc1
    buffer_load_dwordx4 v[52:55], v1, s[36:39], s0 offen offset:1024 sc1
    buffer_load_dwordx4 v[56:59], v1, s[36:39], s0 offen offset:2048 sc1
    buffer_load_dwordx4 v[60:63], v1, s[36:39], s0 offen offset:3072 sc1
    buffer_load_dwordx4 v[64:67], v1, s[36:39], s1 offen offset:0 sc1
    buffer_load_dwordx4 v[68:71], v1, s[36:39], s1 offen offset:1024 sc1
    buffer_load_dwordx4 v[72:75], v1, s[36:39], s1 offen offset:2048 sc1
    s_waitcnt vmcnt(14)
    v_max_u32 v4, v48, v49
    v_max3_u32 v4, v4, v50, v51
    v_max3_u32 v4, v4, v52, v53
    v_max3_u32 v4, v4, v54, v55
    v_max3_u32 v4, v4, v56, v57
    v_max3_u32 v4, v4, v58, v59
    v_max3_u32 v4, v4, v60, v61
    v_max3_u32 v4, v4, v62, v63
    v_max3_u32 v4, v4, v64, v65
    v_max3_u32 v4, v4, v66, v67
    v_max3_u32 v4, v4, v68, v69
    v_max3_u32 v4, v4, v70, v71
    v_max3_u32 v4, v4, v72, v73
    v_max3_u32 v4, v4, v74, v75
    v_cmp_eq_u32 vcc, -1, v4
    s_cbranch_vccz POK_24
    s_sub_u32 s57, s57, 1
    s_cbranch_scc0 POLL_23
POK_24:
    v_mfma_f32_16x16x32_bf16 v[40:43], v[20:23], v[48:51], 0
    v_mfma_f32_16x16x32_bf16 v[44:47], v[20:23], v[52:55], 0
    v_mfma_f32_16x16x32_bf16 v[40:43], v[20:23], v[56:59], v[40:43]
    v_mfma_f32_16x16x32_bf16 v[44:47], v[20:23], v[60:63], v[44:47]
    v_mfma_f32_16x16x32_bf16 v[40:43], v[20:23], v[64:67], v[40:43]
    v_mfma_f32_16x16x32_bf16 v[44:47], v[20:23], v[68:71], v[44:47]
    v_mfma_f32_16x16x32_bf16 v[40:43], v[20:23], v[72:75], v[40:43]
    s_waitcnt lgkmcnt(0)
    s_nop 6
    v_pk_add_f32 v[40:41], v[40:41], v[44:45]
    v_pk_fma_f32 v[36:37], v[34:35], v[40:41], v[36:37]
    v_cvt_pk_bf16_f32 v36, v36, v37
    buffer_store_short v36, v15, s[48:51], s33 offen
    buffer_store_short_d16_hi v36, v15, s[48:51], s33 offen offset:8
FIN:
EXIT:
    s_endpgm
.section .rodata,"a"
.p2align 6
.amdhsa_kernel adaLN_cond__compressed_kv_cla__dense_activation_relu__decode_kernel
  .amdhsa_next_free_vgpr 512
  .amdhsa_next_free_sgpr 102
  .amdhsa_accum_offset 256
  .amdhsa_group_segment_fixed_size 0
  .amdhsa_kernarg_size 112
  .amdhsa_user_sgpr_count 2
  .amdhsa_user_sgpr_kernarg_segment_ptr 1
  .amdhsa_system_sgpr_workgroup_id_x 1
.end_amdhsa_kernel
```
